```python
import torch

def _softmax(x, axis=-1):
    return torch.softmax(x, dim=axis)
def _gelu(x):
    return torch.nn.functional.gelu(x, approximate="tanh")
def _silu(x):
    return torch.nn.functional.silu(x)
def _sigmoid(x):
    return torch.sigmoid(x)
def _layernorm(x, axis=-1, eps=1e-5):
    m = x.mean(dim=axis, keepdim=True)
    v = x.var(dim=axis, keepdim=True, unbiased=False)
    return (x - m) / torch.sqrt(v + eps)
def _scatter_add(tgt, idx, src, axis=0):
    return tgt.clone().index_add_(axis, idx, src)
def _segment_sum(src, seg, n):
    out = torch.zeros((n,) + src.shape[1:], dtype=src.dtype)
    return out.index_add_(0, seg, src)
def _pad(x, pw):
    flat = tuple(v for pair in reversed(pw) for v in pair)
    return torch.nn.functional.pad(x, flat)

kernel_name = 'standalone__softmax_full_bidir__prompt'

def setup_inputs():

    _w = (lambda a: (lambda t: t.to(torch.bfloat16) if t.is_floating_point() else t)(torch.as_tensor(a)))
    B, H, Sq, Skv, Dh = 1, 32, 2048, 2048, 128
    return {
        "q": _w((lambda *s: torch.randn(*s, dtype=torch.bfloat16) * 0.8)(B, H, Sq, Dh)),
        "k": _w((lambda *s: torch.randn(*s, dtype=torch.bfloat16) * 0.8)(B, H, Skv, Dh)),
        "v": _w((lambda *s: torch.randn(*s, dtype=torch.bfloat16) * 0.05)(B, H, Skv, Dh)),
    }

def reference(q, k, v):
    scale = q.shape[-1] ** -0.5
    scores = torch.einsum('bhqd,bhkd->bhqk', q, k) * scale
    attn = _softmax(scores, axis=-1)
    return torch.einsum('bhqk,bhkd->bhqd', attn, v)
```

```asm
; @launch grid=(256,1,1) block=(256,1,1) lds=163840
.amdgcn_target "amdgcn-amd-amdhsa--gfx950"
.text
.globl standalone__softmax_full_bidir__prompt_kernel
.p2align 8
.type standalone__softmax_full_bidir__prompt_kernel,@function
standalone__softmax_full_bidir__prompt_kernel:
s_load_dwordx4 s[32:35], s[0:1], 0
s_load_dwordx4 s[36:39], s[0:1], 16
s_cmp_ge_u32 s2, 256
s_cbranch_scc1 L_end
s_getpc_b64 s[46:47]
L_pc:
s_lshr_b32 s5, s2, 3
s_lshl_b32 s5, s5, 10
v_lshrrev_b32 v122, 5, v0
v_lshl_add_u32 v122, v122, 7, s5
v_min_u32 v122, L_fallback-L_pc, v122
v_mov_b32 v123, s47
v_add_co_u32 v122, vcc, s46, v122
s_nop 1
v_addc_co_u32 v123, vcc, 0, v123, vcc
global_load_dword v112, v[122:123], off
v_lshrrev_b32 v1, 6, v0
v_and_b32 v2, 15, v0
v_bfe_u32 v3, v0, 4, 2
v_readfirstlane_b32 s25, v1
s_and_b32 s3, s2, 7
s_lshr_b32 s4, s2, 6
s_lshl2_add_u32 s3, s3, s4
s_lshl_b32 s3, s3, 19
s_bfe_u32 s6, s2, 0x30003
s_lshl_b32 s4, s6, 16
s_add_u32 s4, s4, s3
v_lshl_add_u32 v122, v1, 6, v3
v_lshlrev_b32 v123, 2, v3
v_lshlrev_b32 v122, 8, v122
v_xor_b32 v123, v123, v2
v_lshl_add_u32 v100, v123, 4, v122
s_lshl_b32 s58, s25, 14
s_lshl_b32 s25, s25, 12
s_add_u32 s58, s58, 98304
s_mov_b32 s48, s25
s_mov_b32 s28, 0
v_lshl_add_u32 v122, v1, 4, v3
v_lshl_add_u32 v123, v1, 2, v3
v_lshlrev_b32 v122, 8, v122
v_xor_b32 v96, v123, v2
v_lshl_add_u32 v96, v96, 4, v122
v_add_u32 v97, 16384, v96
s_add_u32 s49, s48, 4096
s_and_b32 s49, s49, 0x3fff
s_waitcnt lgkmcnt(0)
s_add_u32 s16, s32, s4
s_addc_u32 s17, s33, 0
s_and_b32 s17, s17, 0xffff
s_mov_b32 s18, 65536
s_mov_b32 s19, 0x20000
s_add_u32 s8, s34, s3
s_addc_u32 s9, s35, 0
s_and_b32 s9, s9, 0xffff
s_mov_b32 s10, 524288
s_mov_b32 s11, 0x20000
L_restart:
s_add_u32 m0, s58, 0
s_nop 0
buffer_load_dwordx4 v100, s[16:19], s48 offen offset:0 lds
buffer_load_dwordx4 v100, s[16:19], s48 offen offset:1024 lds
buffer_load_dwordx4 v100, s[16:19], s48 offen offset:2048 lds
buffer_load_dwordx4 v100, s[16:19], s48 offen offset:3072 lds
s_add_u32 m0, s25, 0
s_nop 0
buffer_load_dwordx4 v96, s[8:11], 0 offen offset:0 lds
buffer_load_dwordx4 v96, s[8:11], 0 offen offset:1024 lds
buffer_load_dwordx4 v96, s[8:11], 0 offen offset:2048 lds
buffer_load_dwordx4 v96, s[8:11], 0 offen offset:3072 lds
s_add_u32 m0, s58, 4096
s_nop 0
buffer_load_dwordx4 v100, s[16:19], s49 offen offset:0 lds
buffer_load_dwordx4 v100, s[16:19], s49 offen offset:1024 lds
buffer_load_dwordx4 v100, s[16:19], s49 offen offset:2048 lds
buffer_load_dwordx4 v100, s[16:19], s49 offen offset:3072 lds
v_mov_b32 v224, 0
v_mov_b32 v225, 0
v_mov_b32 v226, 0
v_mov_b32 v227, 0
s_nop 1
v_mfma_f32_32x32x16_bf16 a[0:15], v[224:227], v[224:227], 0
s_add_u32 s12, s36, s3
s_addc_u32 s13, s37, 0
s_and_b32 s13, s13, 0xffff
s_mov_b32 s14, 524288
s_mov_b32 s15, 0x20000
s_add_u32 s20, s38, s4
s_addc_u32 s21, s39, 0
s_and_b32 s21, s21, 0xffff
s_mov_b32 s22, 65536
s_mov_b32 s23, 0x20000
s_mov_b32 s40, 32768
s_xor_b32 s50, s48, 8192
v_mfma_f32_32x32x16_bf16 a[16:31], v[224:227], v[224:227], 0
s_xor_b32 s51, s49, 8192
v_lshl_add_u32 v122, v1, 4, v3
v_lshlrev_b32 v122, 8, v122
v_lshl_add_u32 v123, v1, 2, v3
v_and_b32 v123, 7, v123
v_lshlrev_b32 v123, 1, v123
v_xor_b32 v98, v123, v2
v_lshl_add_u32 v98, v98, 4, v122
v_add_u32 v99, 16384, v98
v_lshlrev_b32 v122, 8, v2
v_lshl_add_u32 v122, v3, 4, v122
v_and_b32 v123, 3, v2
v_mfma_f32_32x32x16_bf16 a[32:47], v[224:227], v[224:227], 0
v_lshl_add_u32 v122, v123, 6, v122
v_add_u32 v240, s58, v122
v_xor_b32 v241, 64, v240
v_xor_b32 v242, 128, v240
v_xor_b32 v243, 192, v240
v_lshrrev_b32 v122, 2, v2
v_lshl_add_u32 v122, v122, 4, v123
v_lshlrev_b32 v122, 8, v122
v_xor_b32 v123, v3, v2
v_lshl_add_u32 v4, v123, 4, v122
v_xor_b32 v5, 64, v4
v_xor_b32 v6, 128, v4
v_mfma_f32_32x32x16_bf16 a[48:63], v[224:227], v[224:227], 0
v_xor_b32 v7, 192, v4
v_lshrrev_b32 v123, 2, v2
v_lshl_add_u32 v122, v3, 4, v123
v_lshlrev_b32 v122, 8, v122
v_add_u32 v122, 65536, v122
v_and_b32 v8, 1, v3
v_lshl_add_u32 v123, v8, 2, v123
v_lshl_add_u32 v122, v123, 5, v122
v_and_b32 v123, 3, v2
v_lshl_add_u32 v8, v123, 3, v122
v_xor_b32 v9, 32, v8
v_xor_b32 v10, 64, v8
v_mfma_f32_32x32x16_bf16 a[64:79], v[224:227], v[224:227], 0
v_xor_b32 v11, 96, v8
v_xor_b32 v12, 128, v8
v_xor_b32 v13, 160, v8
v_xor_b32 v14, 192, v8
v_xor_b32 v15, 224, v8
v_and_b32 v123, 3, v2
v_lshl_add_u32 v122, v3, 2, v123
v_lshl_add_u32 v122, v1, 6, v122
v_lshlrev_b32 v122, 8, v122
v_lshrrev_b32 v116, 2, v2
v_lshl_add_u32 v101, v116, 4, v122
v_lshl_add_u32 v114, v3, 2, v2
v_mfma_f32_32x32x16_bf16 a[80:95], v[224:227], v[224:227], 0
v_and_b32 v114, 15, v114
v_lshlrev_b32 v114, 2, v114
v_lshl_add_u32 v116, v123, 3, v116
v_lshlrev_b32 v122, 13, v1
v_add_u32 v122, 32768, v122
v_lshl_add_u32 v122, v3, 8, v122
v_and_b32 v123, 1, v3
v_lshlrev_b32 v123, 2, v123
v_xor_b32 v113, v123, v2
v_lshl_add_u32 v113, v113, 3, v122
v_xor_b32 v115, v123, v116
v_lshl_add_u32 v115, v115, 3, v122
v_mfma_f32_32x32x16_bf16 a[96:111], v[224:227], v[224:227], 0
v_xor_b32 v116, 32, v115
v_lshlrev_b32 v110, 2, v1
v_add_u32 v110, 131072, v110
v_mov_b32 v122, 0x3f803f80
v_accvgpr_write_b32 a240, v122
v_accvgpr_write_b32 a241, v122
v_accvgpr_write_b32 a242, v122
v_accvgpr_write_b32 a243, v122
v_and_b32 v127, 1, v0
v_mul_u32_u24 v127, 0xaaaa, v127
v_add_u32 v127, 0x4444, v127
v_lshl_or_b32 v127, v127, 16, v127
v_mfma_f32_32x32x16_bf16 a[112:127], v[224:227], v[224:227], 0
s_mov_b32 s27, 0x3e0293ee
s_mov_b32 s26, 0x3e0293ee
s_mov_b32 s56, 0x07060302
s_lshl_b32 s7, s6, 2
s_lshr_b32 s5, s25, 12
s_add_u32 s7, s7, s5
v_and_b32 v122, 63, v0
s_lshl_b32 s5, s7, 10
v_lshl_add_u32 v124, v122, 4, s5
s_mul_i32 s5, s7, 1024
s_add_u32 s5, s5, 491520
v_mul_u32_u24 v111, 16, v122
v_mfma_f32_32x32x16_bf16 a[224:239], v[224:227], v[224:227], 0
v_add_u32 v111, s5, v111
s_mul_i32 s5, s7, 2048
s_add_u32 s5, s5, 458752
v_mul_u32_u24 v117, 32, v122
v_add_u32 v117, s5, v117
v_mul_u32_u24 v120, 64, v0
v_add_u32 v120, L_final-L_pc, v120
v_min_u32 v120, L_fallback-L_pc, v120
v_mov_b32 v121, s47
v_add_co_u32 v120, vcc, s46, v120
s_nop 1
v_addc_co_u32 v121, vcc, 0, v121, vcc
s_cmp_eq_u32 s28, 0
s_cselect_b64 vcc, -1, 0
v_mov_b32 v122, 0xff800000
v_cndmask_b32 v102, v102, v122, vcc
v_cndmask_b32 v103, v103, v122, vcc
v_cndmask_b32 v104, v104, v122, vcc
v_cndmask_b32 v105, v105, v122, vcc
s_mov_b32 s24, 32768
s_mov_b32 s57, 65536
s_mov_b32 s59, 425984
s_waitcnt vmcnt(8)
ds_read_b128 v[192:195], v240 offset:0
ds_read_b128 v[196:199], v241 offset:0
ds_read_b128 v[200:203], v242 offset:0
ds_read_b128 v[204:207], v243 offset:0
s_waitcnt lgkmcnt(3)
v_lshlrev_b32 v224, 16, v192
v_and_b32 v225, 0xffff0000, v192
v_lshlrev_b32 v226, 16, v193
v_and_b32 v227, 0xffff0000, v193
v_lshlrev_b32 v228, 16, v194
v_and_b32 v229, 0xffff0000, v194
v_lshlrev_b32 v230, 16, v195
v_and_b32 v231, 0xffff0000, v195
v_pk_mul_f32 v[224:225], v[224:225], s[26:27]
v_pk_mul_f32 v[226:227], v[226:227], s[26:27]
v_pk_mul_f32 v[228:229], v[228:229], s[26:27]
v_pk_mul_f32 v[230:231], v[230:231], s[26:27]
v_cvt_pk_bf16_f32 v232, v224, v225
v_cvt_pk_bf16_f32 v233, v226, v227
v_cvt_pk_bf16_f32 v234, v228, v229
v_cvt_pk_bf16_f32 v235, v230, v231
v_accvgpr_write_b32 a128, v232
v_accvgpr_write_b32 a129, v233
v_accvgpr_write_b32 a130, v234
v_accvgpr_write_b32 a131, v235
s_waitcnt lgkmcnt(2)
v_lshlrev_b32 v224, 16, v196
v_and_b32 v225, 0xffff0000, v196
v_lshlrev_b32 v226, 16, v197
v_and_b32 v227, 0xffff0000, v197
v_lshlrev_b32 v228, 16, v198
v_and_b32 v229, 0xffff0000, v198
v_lshlrev_b32 v230, 16, v199
v_and_b32 v231, 0xffff0000, v199
v_pk_mul_f32 v[224:225], v[224:225], s[26:27]
v_pk_mul_f32 v[226:227], v[226:227], s[26:27]
v_pk_mul_f32 v[228:229], v[228:229], s[26:27]
v_pk_mul_f32 v[230:231], v[230:231], s[26:27]
v_cvt_pk_bf16_f32 v232, v224, v225
v_cvt_pk_bf16_f32 v233, v226, v227
v_cvt_pk_bf16_f32 v234, v228, v229
v_cvt_pk_bf16_f32 v235, v230, v231
v_accvgpr_write_b32 a132, v232
v_accvgpr_write_b32 a133, v233
v_accvgpr_write_b32 a134, v234
v_accvgpr_write_b32 a135, v235
s_waitcnt lgkmcnt(1)
v_lshlrev_b32 v224, 16, v200
v_and_b32 v225, 0xffff0000, v200
v_lshlrev_b32 v226, 16, v201
v_and_b32 v227, 0xffff0000, v201
v_lshlrev_b32 v228, 16, v202
v_and_b32 v229, 0xffff0000, v202
v_lshlrev_b32 v230, 16, v203
v_and_b32 v231, 0xffff0000, v203
v_pk_mul_f32 v[224:225], v[224:225], s[26:27]
v_pk_mul_f32 v[226:227], v[226:227], s[26:27]
v_pk_mul_f32 v[228:229], v[228:229], s[26:27]
v_pk_mul_f32 v[230:231], v[230:231], s[26:27]
v_cvt_pk_bf16_f32 v232, v224, v225
v_cvt_pk_bf16_f32 v233, v226, v227
v_cvt_pk_bf16_f32 v234, v228, v229
v_cvt_pk_bf16_f32 v235, v230, v231
v_accvgpr_write_b32 a136, v232
v_accvgpr_write_b32 a137, v233
v_accvgpr_write_b32 a138, v234
v_accvgpr_write_b32 a139, v235
s_waitcnt lgkmcnt(0)
v_lshlrev_b32 v224, 16, v204
v_and_b32 v225, 0xffff0000, v204
v_lshlrev_b32 v226, 16, v205
v_and_b32 v227, 0xffff0000, v205
v_lshlrev_b32 v228, 16, v206
v_and_b32 v229, 0xffff0000, v206
v_lshlrev_b32 v230, 16, v207
v_and_b32 v231, 0xffff0000, v207
v_pk_mul_f32 v[224:225], v[224:225], s[26:27]
v_pk_mul_f32 v[226:227], v[226:227], s[26:27]
v_pk_mul_f32 v[228:229], v[228:229], s[26:27]
v_pk_mul_f32 v[230:231], v[230:231], s[26:27]
v_cvt_pk_bf16_f32 v232, v224, v225
v_cvt_pk_bf16_f32 v233, v226, v227
v_cvt_pk_bf16_f32 v234, v228, v229
v_cvt_pk_bf16_f32 v235, v230, v231
v_accvgpr_write_b32 a140, v232
v_accvgpr_write_b32 a141, v233
v_accvgpr_write_b32 a142, v234
v_accvgpr_write_b32 a143, v235
s_add_u32 m0, s25, 16384
s_nop 0
buffer_load_dwordx4 v97, s[8:11], 0 offen offset:0 lds
buffer_load_dwordx4 v97, s[8:11], 0 offen offset:1024 lds
buffer_load_dwordx4 v97, s[8:11], 0 offen offset:2048 lds
buffer_load_dwordx4 v97, s[8:11], 0 offen offset:3072 lds
buffer_load_dword v112, off, s[12:15], 0
s_waitcnt vmcnt(9)
s_barrier
ds_read_b128 a[160:163], v4 offset:0
ds_read_b128 a[164:167], v5 offset:0
ds_read_b128 a[168:171], v6 offset:0
ds_read_b128 a[172:175], v7 offset:0
s_add_u32 m0, s58, 8192
s_nop 0
buffer_load_dwordx4 v100, s[16:19], s50 offen offset:0 lds
buffer_load_dwordx4 v100, s[16:19], s50 offen offset:1024 lds
buffer_load_dwordx4 v100, s[16:19], s50 offen offset:2048 lds
buffer_load_dwordx4 v100, s[16:19], s50 offen offset:3072 lds
s_waitcnt vmcnt(9)
ds_read_b128 v[192:195], v240 offset:4096
ds_read_b128 v[196:199], v241 offset:4096
ds_read_b128 v[200:203], v242 offset:4096
ds_read_b128 v[204:207], v243 offset:4096
s_waitcnt lgkmcnt(3)
v_lshlrev_b32 v224, 16, v192
v_and_b32 v225, 0xffff0000, v192
v_lshlrev_b32 v226, 16, v193
v_and_b32 v227, 0xffff0000, v193
v_lshlrev_b32 v228, 16, v194
v_and_b32 v229, 0xffff0000, v194
v_lshlrev_b32 v230, 16, v195
v_and_b32 v231, 0xffff0000, v195
v_pk_mul_f32 v[224:225], v[224:225], s[26:27]
v_pk_mul_f32 v[226:227], v[226:227], s[26:27]
v_pk_mul_f32 v[228:229], v[228:229], s[26:27]
v_pk_mul_f32 v[230:231], v[230:231], s[26:27]
v_cvt_pk_bf16_f32 v232, v224, v225
v_cvt_pk_bf16_f32 v233, v226, v227
v_cvt_pk_bf16_f32 v234, v228, v229
v_cvt_pk_bf16_f32 v235, v230, v231
v_accvgpr_write_b32 a144, v232
v_accvgpr_write_b32 a145, v233
v_accvgpr_write_b32 a146, v234
v_accvgpr_write_b32 a147, v235
s_waitcnt lgkmcnt(2)
v_lshlrev_b32 v224, 16, v196
v_and_b32 v225, 0xffff0000, v196
v_lshlrev_b32 v226, 16, v197
v_and_b32 v227, 0xffff0000, v197
v_lshlrev_b32 v228, 16, v198
v_and_b32 v229, 0xffff0000, v198
v_lshlrev_b32 v230, 16, v199
v_and_b32 v231, 0xffff0000, v199
v_pk_mul_f32 v[224:225], v[224:225], s[26:27]
v_pk_mul_f32 v[226:227], v[226:227], s[26:27]
v_pk_mul_f32 v[228:229], v[228:229], s[26:27]
v_pk_mul_f32 v[230:231], v[230:231], s[26:27]
v_cvt_pk_bf16_f32 v232, v224, v225
v_cvt_pk_bf16_f32 v233, v226, v227
v_cvt_pk_bf16_f32 v234, v228, v229
v_cvt_pk_bf16_f32 v235, v230, v231
v_accvgpr_write_b32 a148, v232
v_accvgpr_write_b32 a149, v233
v_accvgpr_write_b32 a150, v234
v_accvgpr_write_b32 a151, v235
s_waitcnt lgkmcnt(1)
v_lshlrev_b32 v224, 16, v200
v_and_b32 v225, 0xffff0000, v200
v_lshlrev_b32 v226, 16, v201
v_and_b32 v227, 0xffff0000, v201
v_lshlrev_b32 v228, 16, v202
v_and_b32 v229, 0xffff0000, v202
v_lshlrev_b32 v230, 16, v203
v_and_b32 v231, 0xffff0000, v203
v_pk_mul_f32 v[224:225], v[224:225], s[26:27]
v_pk_mul_f32 v[226:227], v[226:227], s[26:27]
v_pk_mul_f32 v[228:229], v[228:229], s[26:27]
v_pk_mul_f32 v[230:231], v[230:231], s[26:27]
v_cvt_pk_bf16_f32 v232, v224, v225
v_cvt_pk_bf16_f32 v233, v226, v227
v_cvt_pk_bf16_f32 v234, v228, v229
v_cvt_pk_bf16_f32 v235, v230, v231
v_accvgpr_write_b32 a152, v232
v_accvgpr_write_b32 a153, v233
v_accvgpr_write_b32 a154, v234
v_accvgpr_write_b32 a155, v235
s_waitcnt lgkmcnt(0)
v_lshlrev_b32 v224, 16, v204
v_and_b32 v225, 0xffff0000, v204
v_lshlrev_b32 v226, 16, v205
v_and_b32 v227, 0xffff0000, v205
v_lshlrev_b32 v228, 16, v206
v_and_b32 v229, 0xffff0000, v206
v_lshlrev_b32 v230, 16, v207
v_and_b32 v231, 0xffff0000, v207
v_pk_mul_f32 v[224:225], v[224:225], s[26:27]
v_pk_mul_f32 v[226:227], v[226:227], s[26:27]
v_pk_mul_f32 v[228:229], v[228:229], s[26:27]
v_pk_mul_f32 v[230:231], v[230:231], s[26:27]
v_cvt_pk_bf16_f32 v232, v224, v225
v_cvt_pk_bf16_f32 v233, v226, v227
v_cvt_pk_bf16_f32 v234, v228, v229
v_cvt_pk_bf16_f32 v235, v230, v231
v_accvgpr_write_b32 a156, v232
v_accvgpr_write_b32 a157, v233
v_accvgpr_write_b32 a158, v234
v_accvgpr_write_b32 a159, v235
s_add_u32 m0, s58, 12288
s_nop 0
buffer_load_dwordx4 v100, s[16:19], s51 offen offset:0 lds
buffer_load_dwordx4 v100, s[16:19], s51 offen offset:1024 lds
buffer_load_dwordx4 v100, s[16:19], s51 offen offset:2048 lds
buffer_load_dwordx4 v100, s[16:19], s51 offen offset:3072 lds
v_mfma_f32_16x16x32_bf16 v[16:19], a[160:163], a[128:131], 0
ds_read_b128 a[176:179], v4 offset:1024
ds_read_b128 a[180:183], v5 offset:1024
v_mfma_f32_16x16x32_bf16 v[16:19], a[164:167], a[132:135], v[16:19]
ds_read_b128 a[184:187], v6 offset:1024
ds_read_b128 a[188:191], v7 offset:1024
v_mfma_f32_16x16x32_bf16 v[16:19], a[168:171], a[136:139], v[16:19]
v_mfma_f32_16x16x32_bf16 v[16:19], a[172:175], a[140:143], v[16:19]
v_mfma_f32_16x16x32_bf16 v[20:23], a[172:175], a[156:159], 0
v_mfma_f32_16x16x32_bf16 v[20:23], a[168:171], a[152:155], v[20:23]
v_mfma_f32_16x16x32_bf16 v[20:23], a[164:167], a[148:151], v[20:23]
v_mfma_f32_16x16x32_bf16 v[20:23], a[160:163], a[144:147], v[20:23]
s_nop 3
v_max3_f32 v244, v16, v17, v102
s_waitcnt lgkmcnt(0)
v_mfma_f32_16x16x32_bf16 v[24:27], a[176:179], a[128:131], 0
ds_read_b128 a[160:163], v4 offset:2048
ds_read_b128 a[164:167], v5 offset:2048
v_mfma_f32_16x16x32_bf16 v[24:27], a[180:183], a[132:135], v[24:27]
ds_read_b128 a[168:171], v6 offset:2048
ds_read_b128 a[172:175], v7 offset:2048
v_mfma_f32_16x16x32_bf16 v[24:27], a[184:187], a[136:139], v[24:27]
v_max3_f32 v244, v18, v19, v244
v_mov_b32 v245, v244
v_mfma_f32_16x16x32_bf16 v[24:27], a[188:191], a[140:143], v[24:27]
s_nop 0
v_permlane32_swap_b32 v244, v245
v_max_f32 v244, v244, v245
v_mov_b32 v245, v244
v_mfma_f32_16x16x32_bf16 v[28:31], a[188:191], a[156:159], 0
s_nop 0
v_permlane16_swap_b32 v244, v245
v_max_f32 v244, v244, v245
v_mfma_f32_16x16x32_bf16 v[28:31], a[184:187], a[152:155], v[28:31]
v_sub_f32 v48, 0, v244
v_sub_f32 v49, 0, v244
v_sub_f32 v50, 0, v244
v_mfma_f32_16x16x32_bf16 v[28:31], a[180:183], a[148:151], v[28:31]
v_sub_f32 v51, 0, v244
v_max3_f32 v246, v20, v21, v103
v_max3_f32 v246, v22, v23, v246
v_mov_b32 v247, v246
v_mfma_f32_16x16x32_bf16 v[28:31], a[176:179], a[144:147], v[28:31]
s_nop 0
v_permlane32_swap_b32 v246, v247
s_waitcnt lgkmcnt(0)
v_mfma_f32_16x16x32_bf16 v[32:35], a[160:163], a[128:131], v[48:51]
ds_read_b128 a[176:179], v4 offset:3072
ds_read_b128 a[180:183], v5 offset:3072
ds_read_b128 a[184:187], v6 offset:3072
v_max_f32 v246, v246, v247
v_mfma_f32_16x16x32_bf16 v[32:35], a[164:167], a[132:135], v[32:35]
ds_read_b128 a[188:191], v7 offset:3072
v_mov_b32 v247, v246
v_sub_f32 v16, v16, v244
v_sub_f32 v17, v17, v244
v_sub_f32 v24, v24, v244
v_mfma_f32_16x16x32_bf16 v[32:35], a[168:171], a[136:139], v[32:35]
v_permlane16_swap_b32 v246, v247
v_max_f32 v246, v246, v247
v_sub_f32 v52, 0, v246
v_mfma_f32_16x16x32_bf16 v[32:35], a[172:175], a[140:143], v[32:35]
v_sub_f32 v53, 0, v246
v_sub_f32 v54, 0, v246
v_sub_f32 v55, 0, v246
v_sub_f32 v18, v18, v244
v_sub_f32 v19, v19, v244
v_sub_f32 v25, v25, v244
v_mfma_f32_16x16x32_bf16 v[36:39], a[172:175], a[156:159], v[52:55]
v_exp_f32 v16, v16
v_sub_f32 v20, v20, v246
v_sub_f32 v26, v26, v244
v_sub_f32 v27, v27, v244
v_mfma_f32_16x16x32_bf16 v[36:39], a[168:171], a[152:155], v[36:39]
v_exp_f32 v17, v17
v_exp_f32 v18, v18
v_exp_f32 v24, v24
v_mfma_f32_16x16x32_bf16 v[36:39], a[164:167], a[148:151], v[36:39]
v_cvt_pk_bf16_f32 v128, v16, v17
v_exp_f32 v25, v25
v_exp_f32 v26, v26
v_cvt_pk_bf16_f32 v130, v24, v25
v_mfma_f32_16x16x32_bf16 v[36:39], a[160:163], a[144:147], v[36:39]
v_exp_f32 v19, v19
s_waitcnt lgkmcnt(0)
s_waitcnt vmcnt(9)
s_barrier
v_mfma_f32_16x16x32_bf16 v[40:43], a[176:179], a[128:131], v[48:51]
ds_read_b128 a[160:163], v4 offset:16384
ds_read_b128 a[164:167], v5 offset:16384
ds_read_b128 a[168:171], v6 offset:16384
v_cvt_pk_bf16_f32 v129, v18, v19
v_exp_f32 v27, v27
v_mfma_f32_16x16x32_bf16 v[40:43], a[180:183], a[132:135], v[40:43]
ds_read_b128 a[172:175], v7 offset:16384
v_sub_f32 v21, v21, v246
v_sub_f32 v22, v22, v246
v_cvt_pk_bf16_f32 v131, v26, v27
v_sub_f32 v28, v28, v246
v_sub_f32 v29, v29, v246
v_mfma_f32_16x16x32_bf16 v[40:43], a[184:187], a[136:139], v[40:43]
v_sub_f32 v23, v23, v246
v_exp_f32 v20, v20
v_sub_f32 v30, v30, v246
v_sub_f32 v31, v31, v246
v_mfma_f32_16x16x32_bf16 v[40:43], a[188:191], a[140:143], v[40:43]
v_exp_f32 v21, v21
v_exp_f32 v22, v22
v_cvt_pk_bf16_f32 v144, v20, v21
v_exp_f32 v28, v28
v_mfma_f32_16x16x32_bf16 v[44:47], a[188:191], a[156:159], v[52:55]
v_exp_f32 v29, v29
v_exp_f32 v30, v30
v_cvt_pk_bf16_f32 v146, v28, v29
v_mfma_f32_16x16x32_bf16 v[44:47], a[184:187], a[152:155], v[44:47]
v_exp_f32 v23, v23
v_exp_f32 v31, v31
v_exp_f32 v32, v32
v_mfma_f32_16x16x32_bf16 v[44:47], a[180:183], a[148:151], v[44:47]
v_cvt_pk_bf16_f32 v145, v22, v23
v_cvt_pk_bf16_f32 v147, v30, v31
v_exp_f32 v33, v33
v_exp_f32 v34, v34
v_mfma_f32_16x16x32_bf16 v[44:47], a[176:179], a[144:147], v[44:47]
v_cvt_pk_bf16_f32 v132, v32, v33
v_exp_f32 v35, v35
s_waitcnt lgkmcnt(0)
v_mfma_f32_16x16x32_bf16 v[16:19], a[160:163], a[128:131], v[48:51]
s_add_u32 m0, s25, 65536
s_nop 0
buffer_load_dwordx4 v98, s[12:15], 0 offen offset:0 lds
buffer_load_dwordx4 v98, s[12:15], 0 offen offset:1024 lds
buffer_load_dwordx4 v98, s[12:15], 0 offen offset:2048 lds
buffer_load_dwordx4 v98, s[12:15], 0 offen offset:3072 lds
ds_read_b128 a[176:179], v4 offset:17408
ds_read_b128 a[180:183], v5 offset:17408
v_cvt_pk_bf16_f32 v133, v34, v35
v_mfma_f32_16x16x32_bf16 v[16:19], a[164:167], a[132:135], v[16:19]
ds_read_b128 a[184:187], v6 offset:17408
ds_read_b128 a[188:191], v7 offset:17408
v_exp_f32 v36, v36
v_mfma_f32_16x16x32_bf16 v[16:19], a[168:171], a[136:139], v[16:19]
v_exp_f32 v37, v37
v_exp_f32 v38, v38
v_mfma_f32_16x16x32_bf16 v[16:19], a[172:175], a[140:143], v[16:19]
v_cvt_pk_bf16_f32 v148, v36, v37
v_exp_f32 v39, v39
v_mfma_f32_16x16x32_bf16 v[20:23], a[172:175], a[156:159], v[52:55]
v_cvt_pk_bf16_f32 v149, v38, v39
v_exp_f32 v40, v40
v_mfma_f32_16x16x32_bf16 v[20:23], a[168:171], a[152:155], v[20:23]
v_exp_f32 v41, v41
v_mfma_f32_16x16x32_bf16 v[20:23], a[164:167], a[148:151], v[20:23]
v_exp_f32 v42, v42
v_cvt_pk_bf16_f32 v134, v40, v41
v_mfma_f32_16x16x32_bf16 v[20:23], a[160:163], a[144:147], v[20:23]
v_exp_f32 v43, v43
s_waitcnt lgkmcnt(0)
v_mfma_f32_16x16x32_bf16 v[24:27], a[176:179], a[128:131], v[48:51]
ds_read_b128 a[160:163], v4 offset:18432
ds_read_b128 a[164:167], v5 offset:18432
ds_read_b128 a[168:171], v6 offset:18432
v_cvt_pk_bf16_f32 v135, v42, v43
v_mfma_f32_16x16x32_bf16 v[24:27], a[180:183], a[132:135], v[24:27]
ds_read_b128 a[172:175], v7 offset:18432
v_exp_f32 v44, v44
v_mfma_f32_16x16x32_bf16 v[24:27], a[184:187], a[136:139], v[24:27]
v_exp_f32 v45, v45
v_exp_f32 v46, v46
v_mfma_f32_16x16x32_bf16 v[24:27], a[188:191], a[140:143], v[24:27]
v_cvt_pk_bf16_f32 v150, v44, v45
v_exp_f32 v47, v47
v_mfma_f32_16x16x32_bf16 v[28:31], a[188:191], a[156:159], v[52:55]
v_cvt_pk_bf16_f32 v151, v46, v47
v_exp_f32 v16, v16
v_mfma_f32_16x16x32_bf16 v[28:31], a[184:187], a[152:155], v[28:31]
v_exp_f32 v17, v17
v_mfma_f32_16x16x32_bf16 v[28:31], a[180:183], a[148:151], v[28:31]
v_exp_f32 v18, v18
v_cvt_pk_bf16_f32 v136, v16, v17
v_mfma_f32_16x16x32_bf16 v[28:31], a[176:179], a[144:147], v[28:31]
v_exp_f32 v19, v19
s_waitcnt lgkmcnt(0)
v_mfma_f32_16x16x32_bf16 v[32:35], a[160:163], a[128:131], v[48:51]
s_add_u32 m0, s25, 81920
s_nop 0
buffer_load_dwordx4 v99, s[12:15], 0 offen offset:0 lds
buffer_load_dwordx4 v99, s[12:15], 0 offen offset:1024 lds
buffer_load_dwordx4 v99, s[12:15], 0 offen offset:2048 lds
buffer_load_dwordx4 v99, s[12:15], 0 offen offset:3072 lds
ds_read_b128 a[176:179], v4 offset:19456
ds_read_b128 a[180:183], v5 offset:19456
ds_read_b128 a[184:187], v6 offset:19456
v_cvt_pk_bf16_f32 v137, v18, v19
v_mfma_f32_16x16x32_bf16 v[32:35], a[164:167], a[132:135], v[32:35]
ds_read_b128 a[188:191], v7 offset:19456
v_exp_f32 v20, v20
v_mfma_f32_16x16x32_bf16 v[32:35], a[168:171], a[136:139], v[32:35]
v_exp_f32 v21, v21
v_exp_f32 v22, v22
v_mfma_f32_16x16x32_bf16 v[32:35], a[172:175], a[140:143], v[32:35]
v_cvt_pk_bf16_f32 v152, v20, v21
v_mfma_f32_16x16x32_bf16 v[36:39], a[172:175], a[156:159], v[52:55]
v_exp_f32 v23, v23
v_exp_f32 v24, v24
v_mfma_f32_16x16x32_bf16 v[36:39], a[168:171], a[152:155], v[36:39]
v_cvt_pk_bf16_f32 v153, v22, v23
v_exp_f32 v25, v25
v_mfma_f32_16x16x32_bf16 v[36:39], a[164:167], a[148:151], v[36:39]
v_exp_f32 v26, v26
v_cvt_pk_bf16_f32 v138, v24, v25
v_mfma_f32_16x16x32_bf16 v[36:39], a[160:163], a[144:147], v[36:39]
v_exp_f32 v27, v27
s_waitcnt lgkmcnt(0)
v_mfma_f32_16x16x32_bf16 v[40:43], a[176:179], a[128:131], v[48:51]
v_cvt_pk_bf16_f32 v139, v26, v27
v_exp_f32 v28, v28
v_mfma_f32_16x16x32_bf16 v[40:43], a[180:183], a[132:135], v[40:43]
v_exp_f32 v29, v29
v_exp_f32 v30, v30
v_cvt_pk_bf16_f32 v154, v28, v29
v_mfma_f32_16x16x32_bf16 v[40:43], a[184:187], a[136:139], v[40:43]
v_exp_f32 v31, v31
v_mfma_f32_16x16x32_bf16 v[40:43], a[188:191], a[140:143], v[40:43]
v_cvt_pk_bf16_f32 v155, v30, v31
v_exp_f32 v32, v32
v_exp_f32 v36, v36
v_mfma_f32_16x16x32_bf16 v[44:47], a[188:191], a[156:159], v[52:55]
v_exp_f32 v33, v33
v_exp_f32 v34, v34
v_mfma_f32_16x16x32_bf16 v[44:47], a[184:187], a[152:155], v[44:47]
v_exp_f32 v37, v37
v_exp_f32 v38, v38
v_mfma_f32_16x16x32_bf16 v[44:47], a[180:183], a[148:151], v[44:47]
v_cvt_pk_bf16_f32 v140, v32, v33
v_exp_f32 v35, v35
v_cvt_pk_bf16_f32 v156, v36, v37
v_mfma_f32_16x16x32_bf16 v[44:47], a[176:179], a[144:147], v[44:47]
v_cvt_pk_bf16_f32 v141, v34, v35
v_exp_f32 v39, v39
s_nop 0
v_cvt_pk_bf16_f32 v157, v38, v39
s_waitcnt vmcnt(12)
ds_read_b128 v[192:195], v240 offset:8192
ds_read_b128 v[196:199], v241 offset:8192
ds_read_b128 v[200:203], v242 offset:8192
ds_read_b128 v[204:207], v243 offset:8192
s_add_u32 m0, s25, 32768
s_nop 0
buffer_load_dwordx4 v96, s[8:11], s40 offen offset:0 lds
buffer_load_dwordx4 v96, s[8:11], s40 offen offset:1024 lds
buffer_load_dwordx4 v96, s[8:11], s40 offen offset:2048 lds
buffer_load_dwordx4 v96, s[8:11], s40 offen offset:3072 lds
v_exp_f32 v40, v40
v_exp_f32 v41, v41
v_exp_f32 v42, v42
v_cvt_pk_bf16_f32 v142, v40, v41
v_exp_f32 v43, v43
s_nop 0
v_cvt_pk_bf16_f32 v143, v42, v43
v_exp_f32 v44, v44
v_exp_f32 v45, v45
v_exp_f32 v46, v46
v_cvt_pk_bf16_f32 v158, v44, v45
v_exp_f32 v47, v47
s_nop 0
v_cvt_pk_bf16_f32 v159, v46, v47
s_waitcnt lgkmcnt(3)
v_lshlrev_b32 v224, 16, v192
v_and_b32 v225, 0xffff0000, v192
v_lshlrev_b32 v226, 16, v193
v_and_b32 v227, 0xffff0000, v193
v_lshlrev_b32 v228, 16, v194
v_and_b32 v229, 0xffff0000, v194
v_lshlrev_b32 v230, 16, v195
v_and_b32 v231, 0xffff0000, v195
v_pk_mul_f32 v[224:225], v[224:225], s[26:27]
v_pk_mul_f32 v[226:227], v[226:227], s[26:27]
v_pk_mul_f32 v[228:229], v[228:229], s[26:27]
v_pk_mul_f32 v[230:231], v[230:231], s[26:27]
v_cvt_pk_bf16_f32 v64, v224, v225
v_cvt_pk_bf16_f32 v65, v226, v227
v_cvt_pk_bf16_f32 v66, v228, v229
v_cvt_pk_bf16_f32 v67, v230, v231
s_waitcnt lgkmcnt(2)
v_lshlrev_b32 v224, 16, v196
v_and_b32 v225, 0xffff0000, v196
v_lshlrev_b32 v226, 16, v197
v_and_b32 v227, 0xffff0000, v197
v_lshlrev_b32 v228, 16, v198
v_and_b32 v229, 0xffff0000, v198
v_lshlrev_b32 v230, 16, v199
v_and_b32 v231, 0xffff0000, v199
v_pk_mul_f32 v[224:225], v[224:225], s[26:27]
v_pk_mul_f32 v[226:227], v[226:227], s[26:27]
v_pk_mul_f32 v[228:229], v[228:229], s[26:27]
v_pk_mul_f32 v[230:231], v[230:231], s[26:27]
v_cvt_pk_bf16_f32 v68, v224, v225
v_cvt_pk_bf16_f32 v69, v226, v227
v_cvt_pk_bf16_f32 v70, v228, v229
v_cvt_pk_bf16_f32 v71, v230, v231
s_waitcnt lgkmcnt(1)
v_lshlrev_b32 v224, 16, v200
v_and_b32 v225, 0xffff0000, v200
v_lshlrev_b32 v226, 16, v201
v_and_b32 v227, 0xffff0000, v201
v_lshlrev_b32 v228, 16, v202
v_and_b32 v229, 0xffff0000, v202
v_lshlrev_b32 v230, 16, v203
v_and_b32 v231, 0xffff0000, v203
v_pk_mul_f32 v[224:225], v[224:225], s[26:27]
v_pk_mul_f32 v[226:227], v[226:227], s[26:27]
v_pk_mul_f32 v[228:229], v[228:229], s[26:27]
v_pk_mul_f32 v[230:231], v[230:231], s[26:27]
v_cvt_pk_bf16_f32 v72, v224, v225
v_cvt_pk_bf16_f32 v73, v226, v227
v_cvt_pk_bf16_f32 v74, v228, v229
v_cvt_pk_bf16_f32 v75, v230, v231
s_waitcnt lgkmcnt(0)
v_lshlrev_b32 v224, 16, v204
v_and_b32 v225, 0xffff0000, v204
v_lshlrev_b32 v226, 16, v205
v_and_b32 v227, 0xffff0000, v205
v_lshlrev_b32 v228, 16, v206
v_and_b32 v229, 0xffff0000, v206
v_lshlrev_b32 v230, 16, v207
v_and_b32 v231, 0xffff0000, v207
v_pk_mul_f32 v[224:225], v[224:225], s[26:27]
v_pk_mul_f32 v[226:227], v[226:227], s[26:27]
v_pk_mul_f32 v[228:229], v[228:229], s[26:27]
v_pk_mul_f32 v[230:231], v[230:231], s[26:27]
v_cvt_pk_bf16_f32 v76, v224, v225
v_cvt_pk_bf16_f32 v77, v226, v227
v_cvt_pk_bf16_f32 v78, v228, v229
v_cvt_pk_bf16_f32 v79, v230, v231
s_waitcnt vmcnt(12)
ds_read_b128 v[192:195], v240 offset:12288
ds_read_b128 v[196:199], v241 offset:12288
ds_read_b128 v[200:203], v242 offset:12288
ds_read_b128 v[204:207], v243 offset:12288
ds_read_b128 a[160:163], v4 offset:0
ds_read_b128 a[164:167], v5 offset:0
ds_read_b128 a[168:171], v6 offset:0
ds_read_b128 a[172:175], v7 offset:0
s_add_u32 m0, s25, 49152
s_nop 0
buffer_load_dwordx4 v97, s[8:11], s40 offen offset:0 lds
buffer_load_dwordx4 v97, s[8:11], s40 offen offset:1024 lds
buffer_load_dwordx4 v97, s[8:11], s40 offen offset:2048 lds
buffer_load_dwordx4 v97, s[8:11], s40 offen offset:3072 lds
s_waitcnt lgkmcnt(7)
v_lshlrev_b32 v224, 16, v192
v_and_b32 v225, 0xffff0000, v192
v_lshlrev_b32 v226, 16, v193
v_and_b32 v227, 0xffff0000, v193
v_lshlrev_b32 v228, 16, v194
v_and_b32 v229, 0xffff0000, v194
v_lshlrev_b32 v230, 16, v195
v_and_b32 v231, 0xffff0000, v195
v_pk_mul_f32 v[224:225], v[224:225], s[26:27]
v_pk_mul_f32 v[226:227], v[226:227], s[26:27]
v_pk_mul_f32 v[228:229], v[228:229], s[26:27]
v_pk_mul_f32 v[230:231], v[230:231], s[26:27]
v_cvt_pk_bf16_f32 v80, v224, v225
v_cvt_pk_bf16_f32 v81, v226, v227
v_cvt_pk_bf16_f32 v82, v228, v229
v_cvt_pk_bf16_f32 v83, v230, v231
s_waitcnt lgkmcnt(6)
v_lshlrev_b32 v224, 16, v196
v_and_b32 v225, 0xffff0000, v196
v_lshlrev_b32 v226, 16, v197
v_and_b32 v227, 0xffff0000, v197
v_lshlrev_b32 v228, 16, v198
v_and_b32 v229, 0xffff0000, v198
v_lshlrev_b32 v230, 16, v199
v_and_b32 v231, 0xffff0000, v199
v_pk_mul_f32 v[224:225], v[224:225], s[26:27]
v_pk_mul_f32 v[226:227], v[226:227], s[26:27]
v_pk_mul_f32 v[228:229], v[228:229], s[26:27]
v_pk_mul_f32 v[230:231], v[230:231], s[26:27]
v_cvt_pk_bf16_f32 v84, v224, v225
v_cvt_pk_bf16_f32 v85, v226, v227
v_cvt_pk_bf16_f32 v86, v228, v229
v_cvt_pk_bf16_f32 v87, v230, v231
s_waitcnt lgkmcnt(5)
v_lshlrev_b32 v224, 16, v200
v_and_b32 v225, 0xffff0000, v200
v_lshlrev_b32 v226, 16, v201
v_and_b32 v227, 0xffff0000, v201
v_lshlrev_b32 v228, 16, v202
v_and_b32 v229, 0xffff0000, v202
v_lshlrev_b32 v230, 16, v203
v_and_b32 v231, 0xffff0000, v203
v_pk_mul_f32 v[224:225], v[224:225], s[26:27]
v_pk_mul_f32 v[226:227], v[226:227], s[26:27]
v_pk_mul_f32 v[228:229], v[228:229], s[26:27]
v_pk_mul_f32 v[230:231], v[230:231], s[26:27]
v_cvt_pk_bf16_f32 v88, v224, v225
v_cvt_pk_bf16_f32 v89, v226, v227
v_cvt_pk_bf16_f32 v90, v228, v229
v_cvt_pk_bf16_f32 v91, v230, v231
s_waitcnt lgkmcnt(4)
v_lshlrev_b32 v224, 16, v204
v_and_b32 v225, 0xffff0000, v204
v_lshlrev_b32 v226, 16, v205
v_and_b32 v227, 0xffff0000, v205
v_lshlrev_b32 v228, 16, v206
v_and_b32 v229, 0xffff0000, v206
v_lshlrev_b32 v230, 16, v207
v_and_b32 v231, 0xffff0000, v207
v_pk_mul_f32 v[224:225], v[224:225], s[26:27]
v_pk_mul_f32 v[226:227], v[226:227], s[26:27]
v_pk_mul_f32 v[228:229], v[228:229], s[26:27]
v_pk_mul_f32 v[230:231], v[230:231], s[26:27]
v_cvt_pk_bf16_f32 v92, v224, v225
v_cvt_pk_bf16_f32 v93, v226, v227
v_cvt_pk_bf16_f32 v94, v228, v229
v_cvt_pk_bf16_f32 v95, v230, v231
s_waitcnt lgkmcnt(0)
v_mfma_f32_16x16x32_bf16 v[16:19], a[160:163], v[64:67], 0
ds_read_b128 a[176:179], v4 offset:1024
ds_read_b128 a[180:183], v5 offset:1024
v_mfma_f32_16x16x32_bf16 v[16:19], a[164:167], v[68:71], v[16:19]
ds_read_b128 a[184:187], v6 offset:1024
ds_read_b128 a[188:191], v7 offset:1024
v_mfma_f32_16x16x32_bf16 v[16:19], a[168:171], v[72:75], v[16:19]
v_mfma_f32_16x16x32_bf16 v[16:19], a[172:175], v[76:79], v[16:19]
v_mfma_f32_16x16x32_bf16 v[20:23], a[172:175], v[92:95], 0
v_mfma_f32_16x16x32_bf16 v[20:23], a[168:171], v[88:91], v[20:23]
v_mfma_f32_16x16x32_bf16 v[20:23], a[164:167], v[84:87], v[20:23]
v_mfma_f32_16x16x32_bf16 v[20:23], a[160:163], v[80:83], v[20:23]
s_nop 3
v_max3_f32 v244, v16, v17, v104
s_waitcnt lgkmcnt(0)
v_mfma_f32_16x16x32_bf16 v[32:35], a[176:179], v[64:67], 0
ds_read_b128 a[160:163], v4 offset:2048
ds_read_b128 a[164:167], v5 offset:2048
v_mfma_f32_16x16x32_bf16 v[32:35], a[180:183], v[68:71], v[32:35]
ds_read_b128 a[168:171], v6 offset:2048
ds_read_b128 a[172:175], v7 offset:2048
v_mfma_f32_16x16x32_bf16 v[32:35], a[184:187], v[72:75], v[32:35]
v_max3_f32 v244, v18, v19, v244
v_mov_b32 v245, v244
v_mfma_f32_16x16x32_bf16 v[32:35], a[188:191], v[76:79], v[32:35]
s_nop 0
v_permlane32_swap_b32 v244, v245
v_max_f32 v244, v244, v245
v_mov_b32 v245, v244
v_mfma_f32_16x16x32_bf16 v[36:39], a[188:191], v[92:95], 0
s_nop 0
v_permlane16_swap_b32 v244, v245
v_max_f32 v244, v244, v245
v_mfma_f32_16x16x32_bf16 v[36:39], a[184:187], v[88:91], v[36:39]
v_sub_f32 v56, 0, v244
v_sub_f32 v57, 0, v244
v_sub_f32 v58, 0, v244
v_mfma_f32_16x16x32_bf16 v[36:39], a[180:183], v[84:87], v[36:39]
v_sub_f32 v59, 0, v244
v_max3_f32 v246, v20, v21, v105
v_max3_f32 v246, v22, v23, v246
v_mov_b32 v247, v246
v_mfma_f32_16x16x32_bf16 v[36:39], a[176:179], v[80:83], v[36:39]
s_nop 0
v_permlane32_swap_b32 v246, v247
s_waitcnt lgkmcnt(0)
v_mfma_f32_16x16x32_bf16 v[24:27], a[160:163], v[64:67], v[56:59]
ds_read_b128 a[176:179], v4 offset:3072
ds_read_b128 a[180:183], v5 offset:3072
ds_read_b128 a[184:187], v6 offset:3072
v_max_f32 v246, v246, v247
v_mfma_f32_16x16x32_bf16 v[24:27], a[164:167], v[68:71], v[24:27]
ds_read_b128 a[188:191], v7 offset:3072
v_mov_b32 v247, v246
v_sub_f32 v16, v16, v244
v_sub_f32 v17, v17, v244
v_mfma_f32_16x16x32_bf16 v[24:27], a[168:171], v[72:75], v[24:27]
v_permlane16_swap_b32 v246, v247
v_max_f32 v246, v246, v247
v_sub_f32 v60, 0, v246
v_sub_f32 v61, 0, v246
v_mfma_f32_16x16x32_bf16 v[24:27], a[172:175], v[76:79], v[24:27]
v_sub_f32 v62, 0, v246
v_sub_f32 v63, 0, v246
v_sub_f32 v18, v18, v244
v_sub_f32 v32, v32, v244
v_sub_f32 v33, v33, v244
v_mfma_f32_16x16x32_bf16 v[28:31], a[172:175], v[92:95], v[60:63]
v_sub_f32 v19, v19, v244
v_exp_f32 v16, v16
v_sub_f32 v34, v34, v244
v_sub_f32 v35, v35, v244
v_mfma_f32_16x16x32_bf16 v[28:31], a[168:171], v[88:91], v[28:31]
v_exp_f32 v17, v17
v_exp_f32 v18, v18
v_exp_f32 v32, v32
v_mfma_f32_16x16x32_bf16 v[28:31], a[164:167], v[84:87], v[28:31]
v_cvt_pk_bf16_f32 v160, v16, v17
v_exp_f32 v33, v33
v_exp_f32 v34, v34
v_mfma_f32_16x16x32_bf16 v[28:31], a[160:163], v[80:83], v[28:31]
v_exp_f32 v19, v19
v_cvt_pk_bf16_f32 v162, v32, v33
v_exp_f32 v35, v35
s_waitcnt lgkmcnt(0)
v_mfma_f32_16x16x32_bf16 v[40:43], a[176:179], v[64:67], v[56:59]
ds_read_b128 a[160:163], v4 offset:16384
ds_read_b128 a[164:167], v5 offset:16384
ds_read_b128 a[168:171], v6 offset:16384
v_cvt_pk_bf16_f32 v161, v18, v19
v_sub_f32 v20, v20, v246
v_sub_f32 v21, v21, v246
v_mfma_f32_16x16x32_bf16 v[40:43], a[180:183], v[68:71], v[40:43]
ds_read_b128 a[172:175], v7 offset:16384
v_sub_f32 v22, v22, v246
v_cvt_pk_bf16_f32 v163, v34, v35
v_sub_f32 v36, v36, v246
v_sub_f32 v37, v37, v246
v_mfma_f32_16x16x32_bf16 v[40:43], a[184:187], v[72:75], v[40:43]
v_sub_f32 v23, v23, v246
v_exp_f32 v20, v20
v_sub_f32 v38, v38, v246
v_sub_f32 v39, v39, v246
v_mfma_f32_16x16x32_bf16 v[40:43], a[188:191], v[76:79], v[40:43]
v_exp_f32 v21, v21
v_exp_f32 v22, v22
v_cvt_pk_bf16_f32 v176, v20, v21
v_exp_f32 v36, v36
v_mfma_f32_16x16x32_bf16 v[44:47], a[188:191], v[92:95], v[60:63]
v_exp_f32 v37, v37
v_exp_f32 v38, v38
v_cvt_pk_bf16_f32 v178, v36, v37
v_mfma_f32_16x16x32_bf16 v[44:47], a[184:187], v[88:91], v[44:47]
v_exp_f32 v23, v23
v_exp_f32 v39, v39
v_exp_f32 v24, v24
v_mfma_f32_16x16x32_bf16 v[44:47], a[180:183], v[84:87], v[44:47]
v_cvt_pk_bf16_f32 v177, v22, v23
v_cvt_pk_bf16_f32 v179, v38, v39
v_exp_f32 v25, v25
v_exp_f32 v26, v26
v_mfma_f32_16x16x32_bf16 v[44:47], a[176:179], v[80:83], v[44:47]
v_cvt_pk_bf16_f32 v164, v24, v25
v_exp_f32 v27, v27
s_waitcnt lgkmcnt(0)
v_mfma_f32_16x16x32_bf16 v[16:19], a[160:163], v[64:67], v[56:59]
ds_read_b128 a[176:179], v4 offset:17408
ds_read_b128 a[180:183], v5 offset:17408
v_cvt_pk_bf16_f32 v165, v26, v27
v_mfma_f32_16x16x32_bf16 v[16:19], a[164:167], v[68:71], v[16:19]
ds_read_b128 a[184:187], v6 offset:17408
ds_read_b128 a[188:191], v7 offset:17408
v_exp_f32 v28, v28
v_mfma_f32_16x16x32_bf16 v[16:19], a[168:171], v[72:75], v[16:19]
v_exp_f32 v29, v29
v_exp_f32 v30, v30
v_mfma_f32_16x16x32_bf16 v[16:19], a[172:175], v[76:79], v[16:19]
v_cvt_pk_bf16_f32 v180, v28, v29
v_exp_f32 v31, v31
v_mfma_f32_16x16x32_bf16 v[20:23], a[172:175], v[92:95], v[60:63]
v_cvt_pk_bf16_f32 v181, v30, v31
v_exp_f32 v40, v40
v_mfma_f32_16x16x32_bf16 v[20:23], a[168:171], v[88:91], v[20:23]
v_exp_f32 v41, v41
v_mfma_f32_16x16x32_bf16 v[20:23], a[164:167], v[84:87], v[20:23]
v_exp_f32 v42, v42
v_cvt_pk_bf16_f32 v166, v40, v41
v_mfma_f32_16x16x32_bf16 v[20:23], a[160:163], v[80:83], v[20:23]
v_exp_f32 v43, v43
s_waitcnt lgkmcnt(0)
v_mfma_f32_16x16x32_bf16 v[32:35], a[176:179], v[64:67], v[56:59]
ds_read_b128 a[160:163], v4 offset:18432
ds_read_b128 a[164:167], v5 offset:18432
ds_read_b128 a[168:171], v6 offset:18432
v_cvt_pk_bf16_f32 v167, v42, v43
v_mfma_f32_16x16x32_bf16 v[32:35], a[180:183], v[68:71], v[32:35]
ds_read_b128 a[172:175], v7 offset:18432
v_exp_f32 v44, v44
v_mfma_f32_16x16x32_bf16 v[32:35], a[184:187], v[72:75], v[32:35]
v_exp_f32 v45, v45
v_exp_f32 v46, v46
v_mfma_f32_16x16x32_bf16 v[32:35], a[188:191], v[76:79], v[32:35]
v_cvt_pk_bf16_f32 v182, v44, v45
v_exp_f32 v47, v47
v_mfma_f32_16x16x32_bf16 v[36:39], a[188:191], v[92:95], v[60:63]
v_cvt_pk_bf16_f32 v183, v46, v47
v_exp_f32 v16, v16
v_mfma_f32_16x16x32_bf16 v[36:39], a[184:187], v[88:91], v[36:39]
v_exp_f32 v17, v17
v_mfma_f32_16x16x32_bf16 v[36:39], a[180:183], v[84:87], v[36:39]
v_exp_f32 v18, v18
v_cvt_pk_bf16_f32 v168, v16, v17
v_mfma_f32_16x16x32_bf16 v[36:39], a[176:179], v[80:83], v[36:39]
v_exp_f32 v19, v19
s_waitcnt lgkmcnt(0)
v_mfma_f32_16x16x32_bf16 v[24:27], a[160:163], v[64:67], v[56:59]
ds_read_b128 a[176:179], v4 offset:19456
ds_read_b128 a[180:183], v5 offset:19456
ds_read_b128 a[184:187], v6 offset:19456
v_cvt_pk_bf16_f32 v169, v18, v19
v_mfma_f32_16x16x32_bf16 v[24:27], a[164:167], v[68:71], v[24:27]
ds_read_b128 a[188:191], v7 offset:19456
v_exp_f32 v20, v20
v_mfma_f32_16x16x32_bf16 v[24:27], a[168:171], v[72:75], v[24:27]
v_exp_f32 v21, v21
v_exp_f32 v22, v22
v_mfma_f32_16x16x32_bf16 v[24:27], a[172:175], v[76:79], v[24:27]
v_cvt_pk_bf16_f32 v184, v20, v21
v_exp_f32 v23, v23
v_mfma_f32_16x16x32_bf16 v[28:31], a[172:175], v[92:95], v[60:63]
v_cvt_pk_bf16_f32 v185, v22, v23
v_exp_f32 v32, v32
v_mfma_f32_16x16x32_bf16 v[28:31], a[168:171], v[88:91], v[28:31]
v_exp_f32 v33, v33
v_exp_f32 v34, v34
v_mfma_f32_16x16x32_bf16 v[28:31], a[164:167], v[84:87], v[28:31]
v_cvt_pk_bf16_f32 v170, v32, v33
v_exp_f32 v35, v35
v_mfma_f32_16x16x32_bf16 v[28:31], a[160:163], v[80:83], v[28:31]
v_cvt_pk_bf16_f32 v171, v34, v35
v_exp_f32 v36, v36
s_waitcnt vmcnt(0) lgkmcnt(0)
s_barrier
v_mfma_f32_16x16x32_bf16 v[40:43], a[176:179], v[64:67], v[56:59]
ds_read_b128 a[160:163], v4 offset:32768
ds_read_b128 a[164:167], v5 offset:32768
ds_read_b128 a[168:171], v6 offset:32768
ds_read_b128 a[172:175], v7 offset:32768
v_mfma_f32_16x16x32_bf16 v[40:43], a[180:183], v[68:71], v[40:43]
v_exp_f32 v37, v37
v_exp_f32 v38, v38
v_mfma_f32_16x16x32_bf16 v[40:43], a[184:187], v[72:75], v[40:43]
v_cvt_pk_bf16_f32 v186, v36, v37
v_exp_f32 v39, v39
v_mfma_f32_16x16x32_bf16 v[40:43], a[188:191], v[76:79], v[40:43]
v_cvt_pk_bf16_f32 v187, v38, v39
v_exp_f32 v24, v24
v_exp_f32 v28, v28
v_mfma_f32_16x16x32_bf16 v[44:47], a[188:191], v[92:95], v[60:63]
v_exp_f32 v25, v25
v_exp_f32 v26, v26
v_mfma_f32_16x16x32_bf16 v[44:47], a[184:187], v[88:91], v[44:47]
v_exp_f32 v29, v29
v_exp_f32 v30, v30
v_mfma_f32_16x16x32_bf16 v[44:47], a[180:183], v[84:87], v[44:47]
v_cvt_pk_bf16_f32 v172, v24, v25
v_exp_f32 v27, v27
v_cvt_pk_bf16_f32 v188, v28, v29
v_mfma_f32_16x16x32_bf16 v[44:47], a[176:179], v[80:83], v[44:47]
v_cvt_pk_bf16_f32 v173, v26, v27
v_exp_f32 v31, v31
s_nop 0
v_cvt_pk_bf16_f32 v189, v30, v31
s_waitcnt lgkmcnt(0)
s_branch L_loop
.p2align 6
.fill 8, 4, 0xbf800000
L_touch:
buffer_load_dword v112, v111, s[8:11], 0 offen
buffer_load_dword v112, v117, s[12:15], 0 offen
global_load_dword v112, v[120:121], off
s_mov_b32 s59, 491520
.p2align 6
L_loop:
v_mfma_f32_16x16x32_bf16 v[16:19], a[160:163], a[128:131], v[48:51]
v_exp_f32 v40, v40
v_mfma_f32_16x16x32_bf16 v[16:19], a[164:167], a[132:135], v[16:19]
ds_read_b64_tr_b16 a[176:177], v8 offset:0
ds_read_b64_tr_b16 a[178:179], v8 offset:1024
v_mfma_f32_16x16x32_bf16 v[16:19], a[168:171], a[136:139], v[16:19]
v_exp_f32 v41, v41
v_mfma_f32_16x16x32_bf16 v[16:19], a[172:175], a[140:143], v[16:19]
ds_read_b64_tr_b16 a[180:181], v8 offset:2048
ds_read_b64_tr_b16 a[182:183], v8 offset:3072
v_mfma_f32_16x16x32_bf16 v[20:23], a[172:175], a[156:159], v[52:55]
v_exp_f32 v42, v42
v_mfma_f32_16x16x32_bf16 v[20:23], a[168:171], a[152:155], v[20:23]
ds_read_b64_tr_b16 a[184:185], v8 offset:16384
ds_read_b64_tr_b16 a[186:187], v8 offset:17408
v_mfma_f32_16x16x32_bf16 v[20:23], a[164:167], a[148:151], v[20:23]
v_exp_f32 v43, v43
v_mfma_f32_16x16x32_bf16 v[20:23], a[160:163], a[144:147], v[20:23]
ds_read_b64_tr_b16 a[188:189], v8 offset:18432
ds_read_b64_tr_b16 a[190:191], v8 offset:19456
s_add_u32 m0, s25, 0
v_mfma_f32_16x16x32_bf16 v[24:27], a[160:163], v[64:67], v[56:59]
v_exp_f32 v44, v44
v_mfma_f32_16x16x32_bf16 v[24:27], a[164:167], v[68:71], v[24:27]
buffer_load_dwordx4 v96, s[8:11], s57 offen offset:0 lds
v_mfma_f32_16x16x32_bf16 v[24:27], a[168:171], v[72:75], v[24:27]
v_exp_f32 v45, v45
v_mfma_f32_16x16x32_bf16 v[24:27], a[172:175], v[76:79], v[24:27]
buffer_load_dwordx4 v96, s[8:11], s57 offen offset:1024 lds
v_mfma_f32_16x16x32_bf16 v[28:31], a[172:175], v[92:95], v[60:63]
v_exp_f32 v46, v46
v_mfma_f32_16x16x32_bf16 v[28:31], a[168:171], v[88:91], v[28:31]
v_cvt_pk_bf16_f32 v174, v40, v41
v_cvt_pk_bf16_f32 v175, v42, v43
v_mfma_f32_16x16x32_bf16 v[28:31], a[164:167], v[84:87], v[28:31]
v_exp_f32 v47, v47
v_mfma_f32_16x16x32_bf16 v[28:31], a[160:163], v[80:83], v[28:31]
v_cvt_pk_bf16_f32 v190, v44, v45
s_waitcnt lgkmcnt(0)
v_mfma_f32_16x16x32_bf16 a[0:3], v[128:131], a[176:179], a[0:3]
v_exp_f32 v16, v16
v_mfma_f32_16x16x32_bf16 a[0:3], v[132:135], a[180:183], a[0:3]
ds_read_b128 a[160:163], v4 offset:33792
ds_read_b128 a[164:167], v5 offset:33792
v_mfma_f32_16x16x32_bf16 a[0:3], v[136:139], a[184:187], a[0:3]
v_exp_f32 v17, v17
v_mfma_f32_16x16x32_bf16 a[0:3], v[140:143], a[188:191], a[0:3]
ds_read_b128 a[168:171], v6 offset:33792
ds_read_b128 a[172:175], v7 offset:33792
v_mfma_f32_16x16x32_bf16 a[4:7], v[156:159], a[188:191], a[4:7]
v_exp_f32 v18, v18
v_mfma_f32_16x16x32_bf16 a[4:7], v[152:155], a[184:187], a[4:7]
v_cvt_pk_bf16_f32 v191, v46, v47
v_cvt_pk_bf16_f32 v192, v16, v17
v_mfma_f32_16x16x32_bf16 a[4:7], v[148:151], a[180:183], a[4:7]
v_exp_f32 v19, v19
v_mfma_f32_16x16x32_bf16 a[4:7], v[144:147], a[176:179], a[4:7]
buffer_load_dwordx4 v96, s[8:11], s57 offen offset:2048 lds
v_mfma_f32_16x16x32_bf16 a[8:11], v[160:163], a[176:179], a[8:11]
v_exp_f32 v20, v20
v_mfma_f32_16x16x32_bf16 a[8:11], v[164:167], a[180:183], a[8:11]
v_cvt_pk_bf16_f32 v193, v18, v19
v_mfma_f32_16x16x32_bf16 a[8:11], v[168:171], a[184:187], a[8:11]
v_exp_f32 v21, v21
v_mfma_f32_16x16x32_bf16 a[8:11], v[172:175], a[188:191], a[8:11]
buffer_load_dwordx4 v96, s[8:11], s57 offen offset:3072 lds
v_mfma_f32_16x16x32_bf16 a[12:15], v[188:191], a[188:191], a[12:15]
v_exp_f32 v22, v22
v_mfma_f32_16x16x32_bf16 a[12:15], v[184:187], a[184:187], a[12:15]
v_cvt_pk_bf16_f32 v208, v20, v21
s_add_u32 m0, s25, 16384
v_mfma_f32_16x16x32_bf16 a[12:15], v[180:183], a[180:183], a[12:15]
v_exp_f32 v23, v23
v_mfma_f32_16x16x32_bf16 a[12:15], v[176:179], a[176:179], a[12:15]
v_cvt_pk_bf16_f32 v209, v22, v23
s_waitcnt lgkmcnt(0)
v_mfma_f32_16x16x32_bf16 v[32:35], a[160:163], a[128:131], v[48:51]
v_exp_f32 v24, v24
v_mfma_f32_16x16x32_bf16 v[32:35], a[164:167], a[132:135], v[32:35]
ds_read_b64_tr_b16 a[176:177], v9 offset:0
ds_read_b64_tr_b16 a[178:179], v9 offset:1024
v_mfma_f32_16x16x32_bf16 v[32:35], a[168:171], a[136:139], v[32:35]
v_exp_f32 v25, v25
v_mfma_f32_16x16x32_bf16 v[32:35], a[172:175], a[140:143], v[32:35]
ds_read_b64_tr_b16 a[180:181], v9 offset:2048
ds_read_b64_tr_b16 a[182:183], v9 offset:3072
v_mfma_f32_16x16x32_bf16 v[36:39], a[172:175], a[156:159], v[52:55]
v_exp_f32 v26, v26
v_mfma_f32_16x16x32_bf16 v[36:39], a[168:171], a[152:155], v[36:39]
ds_read_b64_tr_b16 a[184:185], v9 offset:16384
ds_read_b64_tr_b16 a[186:187], v9 offset:17408
v_mfma_f32_16x16x32_bf16 v[36:39], a[164:167], a[148:151], v[36:39]
v_exp_f32 v27, v27
v_mfma_f32_16x16x32_bf16 v[36:39], a[160:163], a[144:147], v[36:39]
ds_read_b64_tr_b16 a[188:189], v9 offset:18432
ds_read_b64_tr_b16 a[190:191], v9 offset:19456
v_mfma_f32_16x16x32_bf16 v[40:43], a[160:163], v[64:67], v[56:59]
v_exp_f32 v28, v28
v_mfma_f32_16x16x32_bf16 v[40:43], a[164:167], v[68:71], v[40:43]
buffer_load_dwordx4 v97, s[8:11], s57 offen offset:0 lds
v_mfma_f32_16x16x32_bf16 v[40:43], a[168:171], v[72:75], v[40:43]
v_exp_f32 v29, v29
v_mfma_f32_16x16x32_bf16 v[40:43], a[172:175], v[76:79], v[40:43]
buffer_load_dwordx4 v97, s[8:11], s57 offen offset:1024 lds
v_mfma_f32_16x16x32_bf16 v[44:47], a[172:175], v[92:95], v[60:63]
v_exp_f32 v30, v30
v_mfma_f32_16x16x32_bf16 v[44:47], a[168:171], v[88:91], v[44:47]
v_cvt_pk_bf16_f32 v224, v24, v25
v_cvt_pk_bf16_f32 v225, v26, v27
v_mfma_f32_16x16x32_bf16 v[44:47], a[164:167], v[84:87], v[44:47]
v_exp_f32 v31, v31
v_mfma_f32_16x16x32_bf16 v[44:47], a[160:163], v[80:83], v[44:47]
v_cvt_pk_bf16_f32 v240, v28, v29
s_waitcnt lgkmcnt(0)
v_mfma_f32_16x16x32_bf16 a[16:19], v[128:131], a[176:179], a[16:19]
v_exp_f32 v32, v32
v_mfma_f32_16x16x32_bf16 a[16:19], v[132:135], a[180:183], a[16:19]
ds_read_b128 a[160:163], v4 offset:34816
ds_read_b128 a[164:167], v5 offset:34816
v_mfma_f32_16x16x32_bf16 a[16:19], v[136:139], a[184:187], a[16:19]
v_exp_f32 v33, v33
v_mfma_f32_16x16x32_bf16 a[16:19], v[140:143], a[188:191], a[16:19]
ds_read_b128 a[168:171], v6 offset:34816
ds_read_b128 a[172:175], v7 offset:34816
v_mfma_f32_16x16x32_bf16 a[20:23], v[156:159], a[188:191], a[20:23]
v_exp_f32 v34, v34
v_mfma_f32_16x16x32_bf16 a[20:23], v[152:155], a[184:187], a[20:23]
buffer_load_dwordx4 v97, s[8:11], s57 offen offset:2048 lds
v_mfma_f32_16x16x32_bf16 a[20:23], v[148:151], a[180:183], a[20:23]
v_exp_f32 v35, v35
v_mfma_f32_16x16x32_bf16 a[20:23], v[144:147], a[176:179], a[20:23]
v_cvt_pk_bf16_f32 v241, v30, v31
v_cvt_pk_bf16_f32 v194, v32, v33
v_mfma_f32_16x16x32_bf16 a[24:27], v[160:163], a[176:179], a[24:27]
v_exp_f32 v36, v36
v_mfma_f32_16x16x32_bf16 a[24:27], v[164:167], a[180:183], a[24:27]
v_cvt_pk_bf16_f32 v195, v34, v35
v_mfma_f32_16x16x32_bf16 a[24:27], v[168:171], a[184:187], a[24:27]
v_exp_f32 v37, v37
v_mfma_f32_16x16x32_bf16 a[24:27], v[172:175], a[188:191], a[24:27]
buffer_load_dwordx4 v97, s[8:11], s57 offen offset:3072 lds
v_mfma_f32_16x16x32_bf16 a[28:31], v[188:191], a[188:191], a[28:31]
v_exp_f32 v38, v38
v_mfma_f32_16x16x32_bf16 a[28:31], v[184:187], a[184:187], a[28:31]
v_cvt_pk_bf16_f32 v210, v36, v37
v_mfma_f32_16x16x32_bf16 a[28:31], v[180:183], a[180:183], a[28:31]
v_exp_f32 v39, v39
v_mfma_f32_16x16x32_bf16 a[28:31], v[176:179], a[176:179], a[28:31]
v_cvt_pk_bf16_f32 v211, v38, v39
s_add_u32 m0, s25, 98304
v_smfmac_f32_16x16x64_bf16 a[224:227], a[240:243], v[128:135], v127
v_smfmac_f32_16x16x64_bf16 a[224:227], a[240:243], v[136:143], v127
s_waitcnt lgkmcnt(0)
v_mfma_f32_16x16x32_bf16 v[16:19], a[160:163], a[128:131], v[48:51]
v_exp_f32 v40, v40
v_mfma_f32_16x16x32_bf16 v[16:19], a[164:167], a[132:135], v[16:19]
ds_read_b64_tr_b16 a[176:177], v10 offset:0
ds_read_b64_tr_b16 a[178:179], v10 offset:1024
v_mfma_f32_16x16x32_bf16 v[16:19], a[168:171], a[136:139], v[16:19]
v_exp_f32 v41, v41
v_mfma_f32_16x16x32_bf16 v[16:19], a[172:175], a[140:143], v[16:19]
ds_read_b64_tr_b16 a[180:181], v10 offset:2048
ds_read_b64_tr_b16 a[182:183], v10 offset:3072
v_mfma_f32_16x16x32_bf16 v[20:23], a[172:175], a[156:159], v[52:55]
v_exp_f32 v42, v42
v_mfma_f32_16x16x32_bf16 v[20:23], a[168:171], a[152:155], v[20:23]
ds_read_b64_tr_b16 a[184:185], v10 offset:16384
ds_read_b64_tr_b16 a[186:187], v10 offset:17408
v_mfma_f32_16x16x32_bf16 v[20:23], a[164:167], a[148:151], v[20:23]
v_exp_f32 v43, v43
v_mfma_f32_16x16x32_bf16 v[20:23], a[160:163], a[144:147], v[20:23]
ds_read_b64_tr_b16 a[188:189], v10 offset:18432
ds_read_b64_tr_b16 a[190:191], v10 offset:19456
v_mfma_f32_16x16x32_bf16 v[24:27], a[160:163], v[64:67], v[56:59]
v_exp_f32 v44, v44
v_mfma_f32_16x16x32_bf16 v[24:27], a[164:167], v[68:71], v[24:27]
buffer_load_dwordx4 v98, s[12:15], s24 offen offset:0 lds
v_mfma_f32_16x16x32_bf16 v[24:27], a[168:171], v[72:75], v[24:27]
v_exp_f32 v45, v45
v_mfma_f32_16x16x32_bf16 v[24:27], a[172:175], v[76:79], v[24:27]
buffer_load_dwordx4 v98, s[12:15], s24 offen offset:1024 lds
v_mfma_f32_16x16x32_bf16 v[28:31], a[172:175], v[92:95], v[60:63]
v_exp_f32 v46, v46
v_mfma_f32_16x16x32_bf16 v[28:31], a[168:171], v[88:91], v[28:31]
v_cvt_pk_bf16_f32 v226, v40, v41
v_cvt_pk_bf16_f32 v227, v42, v43
v_mfma_f32_16x16x32_bf16 v[28:31], a[164:167], v[84:87], v[28:31]
v_exp_f32 v47, v47
v_mfma_f32_16x16x32_bf16 v[28:31], a[160:163], v[80:83], v[28:31]
v_cvt_pk_bf16_f32 v242, v44, v45
s_waitcnt lgkmcnt(0)
v_mfma_f32_16x16x32_bf16 a[32:35], v[128:131], a[176:179], a[32:35]
v_exp_f32 v16, v16
v_mfma_f32_16x16x32_bf16 a[32:35], v[132:135], a[180:183], a[32:35]
ds_read_b128 a[160:163], v4 offset:35840
ds_read_b128 a[164:167], v5 offset:35840
v_mfma_f32_16x16x32_bf16 a[32:35], v[136:139], a[184:187], a[32:35]
v_exp_f32 v17, v17
v_mfma_f32_16x16x32_bf16 a[32:35], v[140:143], a[188:191], a[32:35]
ds_read_b128 a[168:171], v6 offset:35840
ds_read_b128 a[172:175], v7 offset:35840
v_mfma_f32_16x16x32_bf16 a[36:39], v[156:159], a[188:191], a[36:39]
v_exp_f32 v18, v18
v_mfma_f32_16x16x32_bf16 a[36:39], v[152:155], a[184:187], a[36:39]
buffer_load_dwordx4 v98, s[12:15], s24 offen offset:2048 lds
v_mfma_f32_16x16x32_bf16 a[36:39], v[148:151], a[180:183], a[36:39]
v_exp_f32 v19, v19
v_mfma_f32_16x16x32_bf16 a[36:39], v[144:147], a[176:179], a[36:39]
v_cvt_pk_bf16_f32 v243, v46, v47
v_cvt_pk_bf16_f32 v196, v16, v17
v_mfma_f32_16x16x32_bf16 a[40:43], v[160:163], a[176:179], a[40:43]
v_exp_f32 v20, v20
v_mfma_f32_16x16x32_bf16 a[40:43], v[164:167], a[180:183], a[40:43]
v_cvt_pk_bf16_f32 v197, v18, v19
v_mfma_f32_16x16x32_bf16 a[40:43], v[168:171], a[184:187], a[40:43]
v_exp_f32 v21, v21
v_mfma_f32_16x16x32_bf16 a[40:43], v[172:175], a[188:191], a[40:43]
buffer_load_dwordx4 v98, s[12:15], s24 offen offset:3072 lds
v_mfma_f32_16x16x32_bf16 a[44:47], v[188:191], a[188:191], a[44:47]
v_exp_f32 v22, v22
v_mfma_f32_16x16x32_bf16 a[44:47], v[184:187], a[184:187], a[44:47]
v_cvt_pk_bf16_f32 v212, v20, v21
s_add_u32 m0, s25, 114688
v_mfma_f32_16x16x32_bf16 a[44:47], v[180:183], a[180:183], a[44:47]
v_exp_f32 v23, v23
v_mfma_f32_16x16x32_bf16 a[44:47], v[176:179], a[176:179], a[44:47]
v_cvt_pk_bf16_f32 v213, v22, v23
s_waitcnt lgkmcnt(0)
v_mfma_f32_16x16x32_bf16 v[32:35], a[160:163], a[128:131], v[48:51]
v_exp_f32 v24, v24
v_mfma_f32_16x16x32_bf16 v[32:35], a[164:167], a[132:135], v[32:35]
ds_read_b64_tr_b16 a[176:177], v11 offset:0
ds_read_b64_tr_b16 a[178:179], v11 offset:1024
v_mfma_f32_16x16x32_bf16 v[32:35], a[168:171], a[136:139], v[32:35]
v_exp_f32 v25, v25
v_mfma_f32_16x16x32_bf16 v[32:35], a[172:175], a[140:143], v[32:35]
ds_read_b64_tr_b16 a[180:181], v11 offset:2048
ds_read_b64_tr_b16 a[182:183], v11 offset:3072
v_mfma_f32_16x16x32_bf16 v[36:39], a[172:175], a[156:159], v[52:55]
v_exp_f32 v26, v26
v_mfma_f32_16x16x32_bf16 v[36:39], a[168:171], a[152:155], v[36:39]
ds_read_b64_tr_b16 a[184:185], v11 offset:16384
ds_read_b64_tr_b16 a[186:187], v11 offset:17408
v_mfma_f32_16x16x32_bf16 v[36:39], a[164:167], a[148:151], v[36:39]
v_exp_f32 v27, v27
v_mfma_f32_16x16x32_bf16 v[36:39], a[160:163], a[144:147], v[36:39]
ds_read_b64_tr_b16 a[188:189], v11 offset:18432
ds_read_b64_tr_b16 a[190:191], v11 offset:19456
v_mfma_f32_16x16x32_bf16 v[40:43], a[160:163], v[64:67], v[56:59]
v_exp_f32 v28, v28
v_mfma_f32_16x16x32_bf16 v[40:43], a[164:167], v[68:71], v[40:43]
buffer_load_dwordx4 v99, s[12:15], s24 offen offset:0 lds
v_mfma_f32_16x16x32_bf16 v[40:43], a[168:171], v[72:75], v[40:43]
v_exp_f32 v29, v29
v_mfma_f32_16x16x32_bf16 v[40:43], a[172:175], v[76:79], v[40:43]
buffer_load_dwordx4 v99, s[12:15], s24 offen offset:1024 lds
v_mfma_f32_16x16x32_bf16 v[44:47], a[172:175], v[92:95], v[60:63]
v_exp_f32 v30, v30
v_mfma_f32_16x16x32_bf16 v[44:47], a[168:171], v[88:91], v[44:47]
v_cvt_pk_bf16_f32 v228, v24, v25
v_cvt_pk_bf16_f32 v229, v26, v27
v_mfma_f32_16x16x32_bf16 v[44:47], a[164:167], v[84:87], v[44:47]
v_exp_f32 v31, v31
v_mfma_f32_16x16x32_bf16 v[44:47], a[160:163], v[80:83], v[44:47]
v_cvt_pk_bf16_f32 v244, v28, v29
s_waitcnt lgkmcnt(0)
v_mfma_f32_16x16x32_bf16 a[48:51], v[128:131], a[176:179], a[48:51]
v_exp_f32 v32, v32
v_mfma_f32_16x16x32_bf16 a[48:51], v[132:135], a[180:183], a[48:51]
ds_read_b128 a[160:163], v4 offset:49152
ds_read_b128 a[164:167], v5 offset:49152
v_mfma_f32_16x16x32_bf16 a[48:51], v[136:139], a[184:187], a[48:51]
v_exp_f32 v33, v33
v_mfma_f32_16x16x32_bf16 a[48:51], v[140:143], a[188:191], a[48:51]
ds_read_b128 a[168:171], v6 offset:49152
ds_read_b128 a[172:175], v7 offset:49152
v_mfma_f32_16x16x32_bf16 a[52:55], v[156:159], a[188:191], a[52:55]
v_exp_f32 v34, v34
v_mfma_f32_16x16x32_bf16 a[52:55], v[152:155], a[184:187], a[52:55]
buffer_load_dwordx4 v99, s[12:15], s24 offen offset:2048 lds
v_mfma_f32_16x16x32_bf16 a[52:55], v[148:151], a[180:183], a[52:55]
v_exp_f32 v35, v35
v_mfma_f32_16x16x32_bf16 a[52:55], v[144:147], a[176:179], a[52:55]
v_cvt_pk_bf16_f32 v245, v30, v31
v_cvt_pk_bf16_f32 v198, v32, v33
v_mfma_f32_16x16x32_bf16 a[56:59], v[160:163], a[176:179], a[56:59]
v_exp_f32 v36, v36
v_mfma_f32_16x16x32_bf16 a[56:59], v[164:167], a[180:183], a[56:59]
v_cvt_pk_bf16_f32 v199, v34, v35
v_mfma_f32_16x16x32_bf16 a[56:59], v[168:171], a[184:187], a[56:59]
v_exp_f32 v37, v37
v_mfma_f32_16x16x32_bf16 a[56:59], v[172:175], a[188:191], a[56:59]
buffer_load_dwordx4 v99, s[12:15], s24 offen offset:3072 lds
v_mfma_f32_16x16x32_bf16 a[60:63], v[188:191], a[188:191], a[60:63]
v_exp_f32 v38, v38
v_mfma_f32_16x16x32_bf16 a[60:63], v[184:187], a[184:187], a[60:63]
v_cvt_pk_bf16_f32 v214, v36, v37
s_add_u32 s24, s24, 32768
v_mfma_f32_16x16x32_bf16 a[60:63], v[180:183], a[180:183], a[60:63]
v_exp_f32 v39, v39
v_mfma_f32_16x16x32_bf16 a[60:63], v[176:179], a[176:179], a[60:63]
v_cvt_pk_bf16_f32 v215, v38, v39
s_add_u32 s57, s57, 32768
v_smfmac_f32_16x16x64_bf16 a[228:231], a[240:243], v[144:151], v127
v_smfmac_f32_16x16x64_bf16 a[228:231], a[240:243], v[152:159], v127
s_waitcnt lgkmcnt(0)
v_mfma_f32_16x16x32_bf16 v[16:19], a[160:163], a[128:131], v[48:51]
v_exp_f32 v40, v40
v_mfma_f32_16x16x32_bf16 v[16:19], a[164:167], a[132:135], v[16:19]
ds_read_b64_tr_b16 a[176:177], v12 offset:0
ds_read_b64_tr_b16 a[178:179], v12 offset:1024
v_mfma_f32_16x16x32_bf16 v[16:19], a[168:171], a[136:139], v[16:19]
v_exp_f32 v41, v41
v_mfma_f32_16x16x32_bf16 v[16:19], a[172:175], a[140:143], v[16:19]
ds_read_b64_tr_b16 a[180:181], v12 offset:2048
ds_read_b64_tr_b16 a[182:183], v12 offset:3072
v_mfma_f32_16x16x32_bf16 v[20:23], a[172:175], a[156:159], v[52:55]
v_exp_f32 v42, v42
v_mfma_f32_16x16x32_bf16 v[20:23], a[168:171], a[152:155], v[20:23]
ds_read_b64_tr_b16 a[184:185], v12 offset:16384
ds_read_b64_tr_b16 a[186:187], v12 offset:17408
v_mfma_f32_16x16x32_bf16 v[20:23], a[164:167], a[148:151], v[20:23]
v_exp_f32 v43, v43
v_mfma_f32_16x16x32_bf16 v[20:23], a[160:163], a[144:147], v[20:23]
ds_read_b64_tr_b16 a[188:189], v12 offset:18432
ds_read_b64_tr_b16 a[190:191], v12 offset:19456
v_mfma_f32_16x16x32_bf16 v[24:27], a[160:163], v[64:67], v[56:59]
v_exp_f32 v44, v44
v_mfma_f32_16x16x32_bf16 v[24:27], a[164:167], v[68:71], v[24:27]
v_cvt_pk_bf16_f32 v230, v40, v41
v_cvt_pk_bf16_f32 v231, v42, v43
v_mfma_f32_16x16x32_bf16 v[24:27], a[168:171], v[72:75], v[24:27]
v_exp_f32 v45, v45
v_mfma_f32_16x16x32_bf16 v[24:27], a[172:175], v[76:79], v[24:27]
v_cvt_pk_bf16_f32 v246, v44, v45
v_mfma_f32_16x16x32_bf16 v[28:31], a[172:175], v[92:95], v[60:63]
v_exp_f32 v46, v46
v_mfma_f32_16x16x32_bf16 v[28:31], a[168:171], v[88:91], v[28:31]
v_mfma_f32_16x16x32_bf16 v[28:31], a[164:167], v[84:87], v[28:31]
v_exp_f32 v47, v47
v_mfma_f32_16x16x32_bf16 v[28:31], a[160:163], v[80:83], v[28:31]
v_cvt_pk_bf16_f32 v247, v46, v47
s_waitcnt lgkmcnt(0)
v_mfma_f32_16x16x32_bf16 a[64:67], v[128:131], a[176:179], a[64:67]
v_exp_f32 v16, v16
v_mfma_f32_16x16x32_bf16 a[64:67], v[132:135], a[180:183], a[64:67]
ds_read_b128 a[160:163], v4 offset:50176
ds_read_b128 a[164:167], v5 offset:50176
v_mfma_f32_16x16x32_bf16 a[64:67], v[136:139], a[184:187], a[64:67]
v_exp_f32 v17, v17
v_mfma_f32_16x16x32_bf16 a[64:67], v[140:143], a[188:191], a[64:67]
ds_read_b128 a[168:171], v6 offset:50176
ds_read_b128 a[172:175], v7 offset:50176
v_mfma_f32_16x16x32_bf16 a[68:71], v[156:159], a[188:191], a[68:71]
v_exp_f32 v18, v18
v_mfma_f32_16x16x32_bf16 a[68:71], v[152:155], a[184:187], a[68:71]
v_cvt_pk_bf16_f32 v200, v16, v17
v_mfma_f32_16x16x32_bf16 a[68:71], v[148:151], a[180:183], a[68:71]
v_exp_f32 v19, v19
v_mfma_f32_16x16x32_bf16 a[68:71], v[144:147], a[176:179], a[68:71]
v_cvt_pk_bf16_f32 v201, v18, v19
v_mfma_f32_16x16x32_bf16 a[72:75], v[160:163], a[176:179], a[72:75]
v_exp_f32 v20, v20
v_mfma_f32_16x16x32_bf16 a[72:75], v[164:167], a[180:183], a[72:75]
v_mfma_f32_16x16x32_bf16 a[72:75], v[168:171], a[184:187], a[72:75]
v_exp_f32 v21, v21
v_mfma_f32_16x16x32_bf16 a[72:75], v[172:175], a[188:191], a[72:75]
v_cvt_pk_bf16_f32 v216, v20, v21
v_mfma_f32_16x16x32_bf16 a[76:79], v[188:191], a[188:191], a[76:79]
v_exp_f32 v22, v22
v_mfma_f32_16x16x32_bf16 a[76:79], v[184:187], a[184:187], a[76:79]
v_mfma_f32_16x16x32_bf16 a[76:79], v[180:183], a[180:183], a[76:79]
v_exp_f32 v23, v23
v_mfma_f32_16x16x32_bf16 a[76:79], v[176:179], a[176:179], a[76:79]
v_cvt_pk_bf16_f32 v217, v22, v23
s_waitcnt lgkmcnt(0)
v_mfma_f32_16x16x32_bf16 v[32:35], a[160:163], a[128:131], v[48:51]
v_exp_f32 v24, v24
v_mfma_f32_16x16x32_bf16 v[32:35], a[164:167], a[132:135], v[32:35]
ds_read_b64_tr_b16 a[176:177], v13 offset:0
ds_read_b64_tr_b16 a[178:179], v13 offset:1024
v_mfma_f32_16x16x32_bf16 v[32:35], a[168:171], a[136:139], v[32:35]
v_exp_f32 v25, v25
v_mfma_f32_16x16x32_bf16 v[32:35], a[172:175], a[140:143], v[32:35]
ds_read_b64_tr_b16 a[180:181], v13 offset:2048
ds_read_b64_tr_b16 a[182:183], v13 offset:3072
v_mfma_f32_16x16x32_bf16 v[36:39], a[172:175], a[156:159], v[52:55]
v_exp_f32 v26, v26
v_mfma_f32_16x16x32_bf16 v[36:39], a[168:171], a[152:155], v[36:39]
ds_read_b64_tr_b16 a[184:185], v13 offset:16384
ds_read_b64_tr_b16 a[186:187], v13 offset:17408
v_mfma_f32_16x16x32_bf16 v[36:39], a[164:167], a[148:151], v[36:39]
v_exp_f32 v27, v27
v_mfma_f32_16x16x32_bf16 v[36:39], a[160:163], a[144:147], v[36:39]
ds_read_b64_tr_b16 a[188:189], v13 offset:18432
ds_read_b64_tr_b16 a[190:191], v13 offset:19456
v_mfma_f32_16x16x32_bf16 v[40:43], a[160:163], v[64:67], v[56:59]
v_exp_f32 v28, v28
v_mfma_f32_16x16x32_bf16 v[40:43], a[164:167], v[68:71], v[40:43]
v_cvt_pk_bf16_f32 v232, v24, v25
v_cvt_pk_bf16_f32 v233, v26, v27
v_mfma_f32_16x16x32_bf16 v[40:43], a[168:171], v[72:75], v[40:43]
v_exp_f32 v29, v29
v_mfma_f32_16x16x32_bf16 v[40:43], a[172:175], v[76:79], v[40:43]
v_cvt_pk_bf16_f32 v248, v28, v29
v_mfma_f32_16x16x32_bf16 v[44:47], a[172:175], v[92:95], v[60:63]
v_exp_f32 v30, v30
v_mfma_f32_16x16x32_bf16 v[44:47], a[168:171], v[88:91], v[44:47]
v_mfma_f32_16x16x32_bf16 v[44:47], a[164:167], v[84:87], v[44:47]
v_exp_f32 v31, v31
v_mfma_f32_16x16x32_bf16 v[44:47], a[160:163], v[80:83], v[44:47]
v_cvt_pk_bf16_f32 v249, v30, v31
s_waitcnt lgkmcnt(0)
v_mfma_f32_16x16x32_bf16 a[80:83], v[128:131], a[176:179], a[80:83]
v_exp_f32 v32, v32
v_mfma_f32_16x16x32_bf16 a[80:83], v[132:135], a[180:183], a[80:83]
ds_read_b128 a[160:163], v4 offset:51200
ds_read_b128 a[164:167], v5 offset:51200
v_mfma_f32_16x16x32_bf16 a[80:83], v[136:139], a[184:187], a[80:83]
v_exp_f32 v33, v33
v_mfma_f32_16x16x32_bf16 a[80:83], v[140:143], a[188:191], a[80:83]
ds_read_b128 a[168:171], v6 offset:51200
ds_read_b128 a[172:175], v7 offset:51200
v_mfma_f32_16x16x32_bf16 a[84:87], v[156:159], a[188:191], a[84:87]
v_exp_f32 v34, v34
v_mfma_f32_16x16x32_bf16 a[84:87], v[152:155], a[184:187], a[84:87]
v_cvt_pk_bf16_f32 v202, v32, v33
v_mfma_f32_16x16x32_bf16 a[84:87], v[148:151], a[180:183], a[84:87]
v_exp_f32 v35, v35
v_mfma_f32_16x16x32_bf16 a[84:87], v[144:147], a[176:179], a[84:87]
v_cvt_pk_bf16_f32 v203, v34, v35
v_mfma_f32_16x16x32_bf16 a[88:91], v[160:163], a[176:179], a[88:91]
v_exp_f32 v36, v36
v_mfma_f32_16x16x32_bf16 a[88:91], v[164:167], a[180:183], a[88:91]
v_mfma_f32_16x16x32_bf16 a[88:91], v[168:171], a[184:187], a[88:91]
v_exp_f32 v37, v37
v_mfma_f32_16x16x32_bf16 a[88:91], v[172:175], a[188:191], a[88:91]
v_cvt_pk_bf16_f32 v218, v36, v37
v_mfma_f32_16x16x32_bf16 a[92:95], v[188:191], a[188:191], a[92:95]
v_exp_f32 v38, v38
v_mfma_f32_16x16x32_bf16 a[92:95], v[184:187], a[184:187], a[92:95]
v_mfma_f32_16x16x32_bf16 a[92:95], v[180:183], a[180:183], a[92:95]
v_exp_f32 v39, v39
v_mfma_f32_16x16x32_bf16 a[92:95], v[176:179], a[176:179], a[92:95]
v_cvt_pk_bf16_f32 v219, v38, v39
v_smfmac_f32_16x16x64_bf16 a[232:235], a[240:243], v[160:167], v127
v_smfmac_f32_16x16x64_bf16 a[232:235], a[240:243], v[168:175], v127
s_waitcnt lgkmcnt(0)
v_mfma_f32_16x16x32_bf16 v[16:19], a[160:163], a[128:131], v[48:51]
v_exp_f32 v40, v40
v_mfma_f32_16x16x32_bf16 v[16:19], a[164:167], a[132:135], v[16:19]
ds_read_b64_tr_b16 a[176:177], v14 offset:0
ds_read_b64_tr_b16 a[178:179], v14 offset:1024
v_mfma_f32_16x16x32_bf16 v[16:19], a[168:171], a[136:139], v[16:19]
v_exp_f32 v41, v41
v_mfma_f32_16x16x32_bf16 v[16:19], a[172:175], a[140:143], v[16:19]
ds_read_b64_tr_b16 a[180:181], v14 offset:2048
ds_read_b64_tr_b16 a[182:183], v14 offset:3072
v_mfma_f32_16x16x32_bf16 v[20:23], a[172:175], a[156:159], v[52:55]
v_exp_f32 v42, v42
v_mfma_f32_16x16x32_bf16 v[20:23], a[168:171], a[152:155], v[20:23]
ds_read_b64_tr_b16 a[184:185], v14 offset:16384
ds_read_b64_tr_b16 a[186:187], v14 offset:17408
v_mfma_f32_16x16x32_bf16 v[20:23], a[164:167], a[148:151], v[20:23]
v_exp_f32 v43, v43
v_mfma_f32_16x16x32_bf16 v[20:23], a[160:163], a[144:147], v[20:23]
ds_read_b64_tr_b16 a[188:189], v14 offset:18432
ds_read_b64_tr_b16 a[190:191], v14 offset:19456
v_mfma_f32_16x16x32_bf16 v[24:27], a[160:163], v[64:67], v[56:59]
v_exp_f32 v44, v44
v_mfma_f32_16x16x32_bf16 v[24:27], a[164:167], v[68:71], v[24:27]
v_cvt_pk_bf16_f32 v234, v40, v41
v_cvt_pk_bf16_f32 v235, v42, v43
v_mfma_f32_16x16x32_bf16 v[24:27], a[168:171], v[72:75], v[24:27]
v_exp_f32 v45, v45
v_mfma_f32_16x16x32_bf16 v[24:27], a[172:175], v[76:79], v[24:27]
v_cvt_pk_bf16_f32 v250, v44, v45
v_mfma_f32_16x16x32_bf16 v[28:31], a[172:175], v[92:95], v[60:63]
v_exp_f32 v46, v46
v_mfma_f32_16x16x32_bf16 v[28:31], a[168:171], v[88:91], v[28:31]
v_mfma_f32_16x16x32_bf16 v[28:31], a[164:167], v[84:87], v[28:31]
v_exp_f32 v47, v47
v_mfma_f32_16x16x32_bf16 v[28:31], a[160:163], v[80:83], v[28:31]
v_cvt_pk_bf16_f32 v251, v46, v47
s_waitcnt lgkmcnt(0)
v_mfma_f32_16x16x32_bf16 a[96:99], v[128:131], a[176:179], a[96:99]
v_exp_f32 v16, v16
v_mfma_f32_16x16x32_bf16 a[96:99], v[132:135], a[180:183], a[96:99]
ds_read_b128 a[160:163], v4 offset:52224
ds_read_b128 a[164:167], v5 offset:52224
v_mfma_f32_16x16x32_bf16 a[96:99], v[136:139], a[184:187], a[96:99]
v_exp_f32 v17, v17
v_mfma_f32_16x16x32_bf16 a[96:99], v[140:143], a[188:191], a[96:99]
ds_read_b128 a[168:171], v6 offset:52224
ds_read_b128 a[172:175], v7 offset:52224
v_mfma_f32_16x16x32_bf16 a[100:103], v[156:159], a[188:191], a[100:103]
v_exp_f32 v18, v18
v_mfma_f32_16x16x32_bf16 a[100:103], v[152:155], a[184:187], a[100:103]
v_cvt_pk_bf16_f32 v204, v16, v17
v_mfma_f32_16x16x32_bf16 a[100:103], v[148:151], a[180:183], a[100:103]
v_exp_f32 v19, v19
v_mfma_f32_16x16x32_bf16 a[100:103], v[144:147], a[176:179], a[100:103]
v_cvt_pk_bf16_f32 v205, v18, v19
v_mfma_f32_16x16x32_bf16 a[104:107], v[160:163], a[176:179], a[104:107]
v_exp_f32 v20, v20
v_mfma_f32_16x16x32_bf16 a[104:107], v[164:167], a[180:183], a[104:107]
v_mfma_f32_16x16x32_bf16 a[104:107], v[168:171], a[184:187], a[104:107]
v_exp_f32 v21, v21
v_mfma_f32_16x16x32_bf16 a[104:107], v[172:175], a[188:191], a[104:107]
v_cvt_pk_bf16_f32 v220, v20, v21
v_mfma_f32_16x16x32_bf16 a[108:111], v[188:191], a[188:191], a[108:111]
v_exp_f32 v22, v22
v_mfma_f32_16x16x32_bf16 a[108:111], v[184:187], a[184:187], a[108:111]
v_mfma_f32_16x16x32_bf16 a[108:111], v[180:183], a[180:183], a[108:111]
v_exp_f32 v23, v23
v_mfma_f32_16x16x32_bf16 a[108:111], v[176:179], a[176:179], a[108:111]
v_cvt_pk_bf16_f32 v221, v22, v23
s_waitcnt lgkmcnt(0)
v_mfma_f32_16x16x32_bf16 v[32:35], a[160:163], a[128:131], v[48:51]
v_exp_f32 v24, v24
v_mfma_f32_16x16x32_bf16 v[32:35], a[164:167], a[132:135], v[32:35]
ds_read_b64_tr_b16 a[176:177], v15 offset:0
ds_read_b64_tr_b16 a[178:179], v15 offset:1024
v_mfma_f32_16x16x32_bf16 v[32:35], a[168:171], a[136:139], v[32:35]
v_exp_f32 v25, v25
v_mfma_f32_16x16x32_bf16 v[32:35], a[172:175], a[140:143], v[32:35]
ds_read_b64_tr_b16 a[180:181], v15 offset:2048
ds_read_b64_tr_b16 a[182:183], v15 offset:3072
v_mfma_f32_16x16x32_bf16 v[36:39], a[172:175], a[156:159], v[52:55]
v_exp_f32 v26, v26
v_mfma_f32_16x16x32_bf16 v[36:39], a[168:171], a[152:155], v[36:39]
ds_read_b64_tr_b16 a[184:185], v15 offset:16384
ds_read_b64_tr_b16 a[186:187], v15 offset:17408
v_mfma_f32_16x16x32_bf16 v[36:39], a[164:167], a[148:151], v[36:39]
v_exp_f32 v27, v27
v_mfma_f32_16x16x32_bf16 v[36:39], a[160:163], a[144:147], v[36:39]
ds_read_b64_tr_b16 a[188:189], v15 offset:18432
ds_read_b64_tr_b16 a[190:191], v15 offset:19456
v_mfma_f32_16x16x32_bf16 v[40:43], a[160:163], v[64:67], v[56:59]
v_exp_f32 v28, v28
v_mfma_f32_16x16x32_bf16 v[40:43], a[164:167], v[68:71], v[40:43]
v_cvt_pk_bf16_f32 v236, v24, v25
v_cvt_pk_bf16_f32 v237, v26, v27
v_mfma_f32_16x16x32_bf16 v[40:43], a[168:171], v[72:75], v[40:43]
v_exp_f32 v29, v29
v_mfma_f32_16x16x32_bf16 v[40:43], a[172:175], v[76:79], v[40:43]
v_cvt_pk_bf16_f32 v252, v28, v29
v_mfma_f32_16x16x32_bf16 v[44:47], a[172:175], v[92:95], v[60:63]
v_exp_f32 v30, v30
v_mfma_f32_16x16x32_bf16 v[44:47], a[168:171], v[88:91], v[44:47]
v_mfma_f32_16x16x32_bf16 v[44:47], a[164:167], v[84:87], v[44:47]
v_exp_f32 v31, v31
v_mfma_f32_16x16x32_bf16 v[44:47], a[160:163], v[80:83], v[44:47]
s_waitcnt vmcnt(0) lgkmcnt(0)
s_barrier
v_mfma_f32_16x16x32_bf16 a[112:115], v[128:131], a[176:179], a[112:115]
v_exp_f32 v32, v32
v_mfma_f32_16x16x32_bf16 a[112:115], v[132:135], a[180:183], a[112:115]
ds_read_b128 a[160:163], v4 offset:0
ds_read_b128 a[164:167], v5 offset:0
v_mfma_f32_16x16x32_bf16 a[112:115], v[136:139], a[184:187], a[112:115]
v_exp_f32 v33, v33
v_mfma_f32_16x16x32_bf16 a[112:115], v[140:143], a[188:191], a[112:115]
ds_read_b128 a[168:171], v6 offset:0
ds_read_b128 a[172:175], v7 offset:0
v_mfma_f32_16x16x32_bf16 a[116:119], v[156:159], a[188:191], a[116:119]
v_exp_f32 v34, v34
v_mfma_f32_16x16x32_bf16 a[116:119], v[152:155], a[184:187], a[116:119]
v_cvt_pk_bf16_f32 v253, v30, v31
v_cvt_pk_bf16_f32 v206, v32, v33
v_mfma_f32_16x16x32_bf16 a[116:119], v[148:151], a[180:183], a[116:119]
v_exp_f32 v35, v35
v_mfma_f32_16x16x32_bf16 a[116:119], v[144:147], a[176:179], a[116:119]
v_cvt_pk_bf16_f32 v207, v34, v35
v_mfma_f32_16x16x32_bf16 a[120:123], v[160:163], a[176:179], a[120:123]
v_exp_f32 v36, v36
v_mfma_f32_16x16x32_bf16 a[120:123], v[164:167], a[180:183], a[120:123]
v_mfma_f32_16x16x32_bf16 a[120:123], v[168:171], a[184:187], a[120:123]
v_exp_f32 v37, v37
v_mfma_f32_16x16x32_bf16 a[120:123], v[172:175], a[188:191], a[120:123]
v_cvt_pk_bf16_f32 v222, v36, v37
v_mfma_f32_16x16x32_bf16 a[124:127], v[188:191], a[188:191], a[124:127]
v_exp_f32 v38, v38
v_mfma_f32_16x16x32_bf16 a[124:127], v[184:187], a[184:187], a[124:127]
v_mfma_f32_16x16x32_bf16 a[124:127], v[180:183], a[180:183], a[124:127]
v_exp_f32 v39, v39
v_mfma_f32_16x16x32_bf16 a[124:127], v[176:179], a[176:179], a[124:127]
v_cvt_pk_bf16_f32 v223, v38, v39
v_smfmac_f32_16x16x64_bf16 a[236:239], a[240:243], v[176:183], v127
v_smfmac_f32_16x16x64_bf16 a[236:239], a[240:243], v[184:191], v127
s_waitcnt lgkmcnt(0)
v_mfma_f32_16x16x32_bf16 v[16:19], a[160:163], a[128:131], v[48:51]
v_exp_f32 v40, v40
v_mfma_f32_16x16x32_bf16 v[16:19], a[164:167], a[132:135], v[16:19]
ds_read_b64_tr_b16 a[176:177], v8 offset:32768
ds_read_b64_tr_b16 a[178:179], v8 offset:33792
v_mfma_f32_16x16x32_bf16 v[16:19], a[168:171], a[136:139], v[16:19]
v_exp_f32 v41, v41
v_mfma_f32_16x16x32_bf16 v[16:19], a[172:175], a[140:143], v[16:19]
ds_read_b64_tr_b16 a[180:181], v8 offset:34816
ds_read_b64_tr_b16 a[182:183], v8 offset:35840
v_mfma_f32_16x16x32_bf16 v[20:23], a[172:175], a[156:159], v[52:55]
v_exp_f32 v42, v42
v_mfma_f32_16x16x32_bf16 v[20:23], a[168:171], a[152:155], v[20:23]
ds_read_b64_tr_b16 a[184:185], v8 offset:49152
ds_read_b64_tr_b16 a[186:187], v8 offset:50176
v_mfma_f32_16x16x32_bf16 v[20:23], a[164:167], a[148:151], v[20:23]
v_exp_f32 v43, v43
v_mfma_f32_16x16x32_bf16 v[20:23], a[160:163], a[144:147], v[20:23]
ds_read_b64_tr_b16 a[188:189], v8 offset:51200
ds_read_b64_tr_b16 a[190:191], v8 offset:52224
s_add_u32 m0, s25, 32768
v_mfma_f32_16x16x32_bf16 v[24:27], a[160:163], v[64:67], v[56:59]
v_exp_f32 v44, v44
v_mfma_f32_16x16x32_bf16 v[24:27], a[164:167], v[68:71], v[24:27]
buffer_load_dwordx4 v96, s[8:11], s57 offen offset:0 lds
v_mfma_f32_16x16x32_bf16 v[24:27], a[168:171], v[72:75], v[24:27]
v_exp_f32 v45, v45
v_mfma_f32_16x16x32_bf16 v[24:27], a[172:175], v[76:79], v[24:27]
buffer_load_dwordx4 v96, s[8:11], s57 offen offset:1024 lds
v_mfma_f32_16x16x32_bf16 v[28:31], a[172:175], v[92:95], v[60:63]
v_exp_f32 v46, v46
v_mfma_f32_16x16x32_bf16 v[28:31], a[168:171], v[88:91], v[28:31]
v_cvt_pk_bf16_f32 v238, v40, v41
v_cvt_pk_bf16_f32 v239, v42, v43
v_mfma_f32_16x16x32_bf16 v[28:31], a[164:167], v[84:87], v[28:31]
v_exp_f32 v47, v47
v_mfma_f32_16x16x32_bf16 v[28:31], a[160:163], v[80:83], v[28:31]
v_cvt_pk_bf16_f32 v254, v44, v45
s_waitcnt lgkmcnt(0)
v_mfma_f32_16x16x32_bf16 a[0:3], v[192:195], a[176:179], a[0:3]
v_exp_f32 v16, v16
v_mfma_f32_16x16x32_bf16 a[0:3], v[196:199], a[180:183], a[0:3]
ds_read_b128 a[160:163], v4 offset:1024
ds_read_b128 a[164:167], v5 offset:1024
v_mfma_f32_16x16x32_bf16 a[0:3], v[200:203], a[184:187], a[0:3]
v_exp_f32 v17, v17
v_mfma_f32_16x16x32_bf16 a[0:3], v[204:207], a[188:191], a[0:3]
ds_read_b128 a[168:171], v6 offset:1024
ds_read_b128 a[172:175], v7 offset:1024
v_mfma_f32_16x16x32_bf16 a[4:7], v[220:223], a[188:191], a[4:7]
v_exp_f32 v18, v18
v_mfma_f32_16x16x32_bf16 a[4:7], v[216:219], a[184:187], a[4:7]
v_cvt_pk_bf16_f32 v255, v46, v47
v_cvt_pk_bf16_f32 v128, v16, v17
v_mfma_f32_16x16x32_bf16 a[4:7], v[212:215], a[180:183], a[4:7]
v_exp_f32 v19, v19
v_mfma_f32_16x16x32_bf16 a[4:7], v[208:211], a[176:179], a[4:7]
buffer_load_dwordx4 v96, s[8:11], s57 offen offset:2048 lds
v_mfma_f32_16x16x32_bf16 a[8:11], v[224:227], a[176:179], a[8:11]
v_exp_f32 v20, v20
v_mfma_f32_16x16x32_bf16 a[8:11], v[228:231], a[180:183], a[8:11]
v_cvt_pk_bf16_f32 v129, v18, v19
v_mfma_f32_16x16x32_bf16 a[8:11], v[232:235], a[184:187], a[8:11]
v_exp_f32 v21, v21
v_mfma_f32_16x16x32_bf16 a[8:11], v[236:239], a[188:191], a[8:11]
buffer_load_dwordx4 v96, s[8:11], s57 offen offset:3072 lds
v_mfma_f32_16x16x32_bf16 a[12:15], v[252:255], a[188:191], a[12:15]
v_exp_f32 v22, v22
v_mfma_f32_16x16x32_bf16 a[12:15], v[248:251], a[184:187], a[12:15]
v_cvt_pk_bf16_f32 v144, v20, v21
s_add_u32 m0, s25, 49152
v_mfma_f32_16x16x32_bf16 a[12:15], v[244:247], a[180:183], a[12:15]
v_exp_f32 v23, v23
v_mfma_f32_16x16x32_bf16 a[12:15], v[240:243], a[176:179], a[12:15]
v_cvt_pk_bf16_f32 v145, v22, v23
s_waitcnt lgkmcnt(0)
v_mfma_f32_16x16x32_bf16 v[32:35], a[160:163], a[128:131], v[48:51]
v_exp_f32 v24, v24
v_mfma_f32_16x16x32_bf16 v[32:35], a[164:167], a[132:135], v[32:35]
ds_read_b64_tr_b16 a[176:177], v9 offset:32768
ds_read_b64_tr_b16 a[178:179], v9 offset:33792
v_mfma_f32_16x16x32_bf16 v[32:35], a[168:171], a[136:139], v[32:35]
v_exp_f32 v25, v25
v_mfma_f32_16x16x32_bf16 v[32:35], a[172:175], a[140:143], v[32:35]
ds_read_b64_tr_b16 a[180:181], v9 offset:34816
ds_read_b64_tr_b16 a[182:183], v9 offset:35840
v_mfma_f32_16x16x32_bf16 v[36:39], a[172:175], a[156:159], v[52:55]
v_exp_f32 v26, v26
v_mfma_f32_16x16x32_bf16 v[36:39], a[168:171], a[152:155], v[36:39]
ds_read_b64_tr_b16 a[184:185], v9 offset:49152
ds_read_b64_tr_b16 a[186:187], v9 offset:50176
v_mfma_f32_16x16x32_bf16 v[36:39], a[164:167], a[148:151], v[36:39]
v_exp_f32 v27, v27
v_mfma_f32_16x16x32_bf16 v[36:39], a[160:163], a[144:147], v[36:39]
ds_read_b64_tr_b16 a[188:189], v9 offset:51200
ds_read_b64_tr_b16 a[190:191], v9 offset:52224
v_mfma_f32_16x16x32_bf16 v[40:43], a[160:163], v[64:67], v[56:59]
v_exp_f32 v28, v28
v_mfma_f32_16x16x32_bf16 v[40:43], a[164:167], v[68:71], v[40:43]
buffer_load_dwordx4 v97, s[8:11], s57 offen offset:0 lds
v_mfma_f32_16x16x32_bf16 v[40:43], a[168:171], v[72:75], v[40:43]
v_exp_f32 v29, v29
v_mfma_f32_16x16x32_bf16 v[40:43], a[172:175], v[76:79], v[40:43]
buffer_load_dwordx4 v97, s[8:11], s57 offen offset:1024 lds
v_mfma_f32_16x16x32_bf16 v[44:47], a[172:175], v[92:95], v[60:63]
v_exp_f32 v30, v30
v_mfma_f32_16x16x32_bf16 v[44:47], a[168:171], v[88:91], v[44:47]
v_cvt_pk_bf16_f32 v160, v24, v25
v_cvt_pk_bf16_f32 v161, v26, v27
v_mfma_f32_16x16x32_bf16 v[44:47], a[164:167], v[84:87], v[44:47]
v_exp_f32 v31, v31
v_mfma_f32_16x16x32_bf16 v[44:47], a[160:163], v[80:83], v[44:47]
v_cvt_pk_bf16_f32 v176, v28, v29
s_waitcnt lgkmcnt(0)
v_mfma_f32_16x16x32_bf16 a[16:19], v[192:195], a[176:179], a[16:19]
v_exp_f32 v32, v32
v_mfma_f32_16x16x32_bf16 a[16:19], v[196:199], a[180:183], a[16:19]
ds_read_b128 a[160:163], v4 offset:2048
ds_read_b128 a[164:167], v5 offset:2048
v_mfma_f32_16x16x32_bf16 a[16:19], v[200:203], a[184:187], a[16:19]
v_exp_f32 v33, v33
v_mfma_f32_16x16x32_bf16 a[16:19], v[204:207], a[188:191], a[16:19]
ds_read_b128 a[168:171], v6 offset:2048
ds_read_b128 a[172:175], v7 offset:2048
v_mfma_f32_16x16x32_bf16 a[20:23], v[220:223], a[188:191], a[20:23]
v_exp_f32 v34, v34
v_mfma_f32_16x16x32_bf16 a[20:23], v[216:219], a[184:187], a[20:23]
buffer_load_dwordx4 v97, s[8:11], s57 offen offset:2048 lds
v_mfma_f32_16x16x32_bf16 a[20:23], v[212:215], a[180:183], a[20:23]
v_exp_f32 v35, v35
v_mfma_f32_16x16x32_bf16 a[20:23], v[208:211], a[176:179], a[20:23]
v_cvt_pk_bf16_f32 v177, v30, v31
v_cvt_pk_bf16_f32 v130, v32, v33
v_mfma_f32_16x16x32_bf16 a[24:27], v[224:227], a[176:179], a[24:27]
v_exp_f32 v36, v36
v_mfma_f32_16x16x32_bf16 a[24:27], v[228:231], a[180:183], a[24:27]
v_cvt_pk_bf16_f32 v131, v34, v35
v_mfma_f32_16x16x32_bf16 a[24:27], v[232:235], a[184:187], a[24:27]
v_exp_f32 v37, v37
v_mfma_f32_16x16x32_bf16 a[24:27], v[236:239], a[188:191], a[24:27]
buffer_load_dwordx4 v97, s[8:11], s57 offen offset:3072 lds
v_mfma_f32_16x16x32_bf16 a[28:31], v[252:255], a[188:191], a[28:31]
v_exp_f32 v38, v38
v_mfma_f32_16x16x32_bf16 a[28:31], v[248:251], a[184:187], a[28:31]
v_cvt_pk_bf16_f32 v146, v36, v37
v_mfma_f32_16x16x32_bf16 a[28:31], v[244:247], a[180:183], a[28:31]
v_exp_f32 v39, v39
v_mfma_f32_16x16x32_bf16 a[28:31], v[240:243], a[176:179], a[28:31]
v_cvt_pk_bf16_f32 v147, v38, v39
s_add_u32 m0, s25, 65536
v_smfmac_f32_16x16x64_bf16 a[224:227], a[240:243], v[192:199], v127
v_smfmac_f32_16x16x64_bf16 a[224:227], a[240:243], v[200:207], v127
s_waitcnt lgkmcnt(0)
v_mfma_f32_16x16x32_bf16 v[16:19], a[160:163], a[128:131], v[48:51]
v_exp_f32 v40, v40
v_mfma_f32_16x16x32_bf16 v[16:19], a[164:167], a[132:135], v[16:19]
ds_read_b64_tr_b16 a[176:177], v10 offset:32768
ds_read_b64_tr_b16 a[178:179], v10 offset:33792
v_mfma_f32_16x16x32_bf16 v[16:19], a[168:171], a[136:139], v[16:19]
v_exp_f32 v41, v41
v_mfma_f32_16x16x32_bf16 v[16:19], a[172:175], a[140:143], v[16:19]
ds_read_b64_tr_b16 a[180:181], v10 offset:34816
ds_read_b64_tr_b16 a[182:183], v10 offset:35840
v_mfma_f32_16x16x32_bf16 v[20:23], a[172:175], a[156:159], v[52:55]
v_exp_f32 v42, v42
v_mfma_f32_16x16x32_bf16 v[20:23], a[168:171], a[152:155], v[20:23]
ds_read_b64_tr_b16 a[184:185], v10 offset:49152
ds_read_b64_tr_b16 a[186:187], v10 offset:50176
v_mfma_f32_16x16x32_bf16 v[20:23], a[164:167], a[148:151], v[20:23]
v_exp_f32 v43, v43
v_mfma_f32_16x16x32_bf16 v[20:23], a[160:163], a[144:147], v[20:23]
ds_read_b64_tr_b16 a[188:189], v10 offset:51200
ds_read_b64_tr_b16 a[190:191], v10 offset:52224
v_mfma_f32_16x16x32_bf16 v[24:27], a[160:163], v[64:67], v[56:59]
v_exp_f32 v44, v44
v_mfma_f32_16x16x32_bf16 v[24:27], a[164:167], v[68:71], v[24:27]
buffer_load_dwordx4 v98, s[12:15], s24 offen offset:0 lds
v_mfma_f32_16x16x32_bf16 v[24:27], a[168:171], v[72:75], v[24:27]
v_exp_f32 v45, v45
v_mfma_f32_16x16x32_bf16 v[24:27], a[172:175], v[76:79], v[24:27]
buffer_load_dwordx4 v98, s[12:15], s24 offen offset:1024 lds
v_mfma_f32_16x16x32_bf16 v[28:31], a[172:175], v[92:95], v[60:63]
v_exp_f32 v46, v46
v_mfma_f32_16x16x32_bf16 v[28:31], a[168:171], v[88:91], v[28:31]
v_cvt_pk_bf16_f32 v162, v40, v41
v_cvt_pk_bf16_f32 v163, v42, v43
v_mfma_f32_16x16x32_bf16 v[28:31], a[164:167], v[84:87], v[28:31]
v_exp_f32 v47, v47
v_mfma_f32_16x16x32_bf16 v[28:31], a[160:163], v[80:83], v[28:31]
v_cvt_pk_bf16_f32 v178, v44, v45
s_waitcnt lgkmcnt(0)
v_mfma_f32_16x16x32_bf16 a[32:35], v[192:195], a[176:179], a[32:35]
v_exp_f32 v16, v16
v_mfma_f32_16x16x32_bf16 a[32:35], v[196:199], a[180:183], a[32:35]
ds_read_b128 a[160:163], v4 offset:3072
ds_read_b128 a[164:167], v5 offset:3072
v_mfma_f32_16x16x32_bf16 a[32:35], v[200:203], a[184:187], a[32:35]
v_exp_f32 v17, v17
v_mfma_f32_16x16x32_bf16 a[32:35], v[204:207], a[188:191], a[32:35]
ds_read_b128 a[168:171], v6 offset:3072
ds_read_b128 a[172:175], v7 offset:3072
v_mfma_f32_16x16x32_bf16 a[36:39], v[220:223], a[188:191], a[36:39]
v_exp_f32 v18, v18
v_mfma_f32_16x16x32_bf16 a[36:39], v[216:219], a[184:187], a[36:39]
buffer_load_dwordx4 v98, s[12:15], s24 offen offset:2048 lds
v_mfma_f32_16x16x32_bf16 a[36:39], v[212:215], a[180:183], a[36:39]
v_exp_f32 v19, v19
v_mfma_f32_16x16x32_bf16 a[36:39], v[208:211], a[176:179], a[36:39]
v_cvt_pk_bf16_f32 v179, v46, v47
v_cvt_pk_bf16_f32 v132, v16, v17
v_mfma_f32_16x16x32_bf16 a[40:43], v[224:227], a[176:179], a[40:43]
v_exp_f32 v20, v20
v_mfma_f32_16x16x32_bf16 a[40:43], v[228:231], a[180:183], a[40:43]
v_cvt_pk_bf16_f32 v133, v18, v19
v_mfma_f32_16x16x32_bf16 a[40:43], v[232:235], a[184:187], a[40:43]
v_exp_f32 v21, v21
v_mfma_f32_16x16x32_bf16 a[40:43], v[236:239], a[188:191], a[40:43]
buffer_load_dwordx4 v98, s[12:15], s24 offen offset:3072 lds
v_mfma_f32_16x16x32_bf16 a[44:47], v[252:255], a[188:191], a[44:47]
v_exp_f32 v22, v22
v_mfma_f32_16x16x32_bf16 a[44:47], v[248:251], a[184:187], a[44:47]
v_cvt_pk_bf16_f32 v148, v20, v21
s_add_u32 m0, s25, 81920
v_mfma_f32_16x16x32_bf16 a[44:47], v[244:247], a[180:183], a[44:47]
v_exp_f32 v23, v23
v_mfma_f32_16x16x32_bf16 a[44:47], v[240:243], a[176:179], a[44:47]
v_cvt_pk_bf16_f32 v149, v22, v23
s_waitcnt lgkmcnt(0)
v_mfma_f32_16x16x32_bf16 v[32:35], a[160:163], a[128:131], v[48:51]
v_exp_f32 v24, v24
v_mfma_f32_16x16x32_bf16 v[32:35], a[164:167], a[132:135], v[32:35]
ds_read_b64_tr_b16 a[176:177], v11 offset:32768
ds_read_b64_tr_b16 a[178:179], v11 offset:33792
v_mfma_f32_16x16x32_bf16 v[32:35], a[168:171], a[136:139], v[32:35]
v_exp_f32 v25, v25
v_mfma_f32_16x16x32_bf16 v[32:35], a[172:175], a[140:143], v[32:35]
ds_read_b64_tr_b16 a[180:181], v11 offset:34816
ds_read_b64_tr_b16 a[182:183], v11 offset:35840
v_mfma_f32_16x16x32_bf16 v[36:39], a[172:175], a[156:159], v[52:55]
v_exp_f32 v26, v26
v_mfma_f32_16x16x32_bf16 v[36:39], a[168:171], a[152:155], v[36:39]
ds_read_b64_tr_b16 a[184:185], v11 offset:49152
ds_read_b64_tr_b16 a[186:187], v11 offset:50176
v_mfma_f32_16x16x32_bf16 v[36:39], a[164:167], a[148:151], v[36:39]
v_exp_f32 v27, v27
v_mfma_f32_16x16x32_bf16 v[36:39], a[160:163], a[144:147], v[36:39]
ds_read_b64_tr_b16 a[188:189], v11 offset:51200
ds_read_b64_tr_b16 a[190:191], v11 offset:52224
v_mfma_f32_16x16x32_bf16 v[40:43], a[160:163], v[64:67], v[56:59]
v_exp_f32 v28, v28
v_mfma_f32_16x16x32_bf16 v[40:43], a[164:167], v[68:71], v[40:43]
buffer_load_dwordx4 v99, s[12:15], s24 offen offset:0 lds
v_mfma_f32_16x16x32_bf16 v[40:43], a[168:171], v[72:75], v[40:43]
v_exp_f32 v29, v29
v_mfma_f32_16x16x32_bf16 v[40:43], a[172:175], v[76:79], v[40:43]
buffer_load_dwordx4 v99, s[12:15], s24 offen offset:1024 lds
v_mfma_f32_16x16x32_bf16 v[44:47], a[172:175], v[92:95], v[60:63]
v_exp_f32 v30, v30
v_mfma_f32_16x16x32_bf16 v[44:47], a[168:171], v[88:91], v[44:47]
v_cvt_pk_bf16_f32 v164, v24, v25
v_cvt_pk_bf16_f32 v165, v26, v27
v_mfma_f32_16x16x32_bf16 v[44:47], a[164:167], v[84:87], v[44:47]
v_exp_f32 v31, v31
v_mfma_f32_16x16x32_bf16 v[44:47], a[160:163], v[80:83], v[44:47]
v_cvt_pk_bf16_f32 v180, v28, v29
s_waitcnt lgkmcnt(0)
v_mfma_f32_16x16x32_bf16 a[48:51], v[192:195], a[176:179], a[48:51]
v_exp_f32 v32, v32
v_mfma_f32_16x16x32_bf16 a[48:51], v[196:199], a[180:183], a[48:51]
ds_read_b128 a[160:163], v4 offset:16384
ds_read_b128 a[164:167], v5 offset:16384
v_mfma_f32_16x16x32_bf16 a[48:51], v[200:203], a[184:187], a[48:51]
v_exp_f32 v33, v33
v_mfma_f32_16x16x32_bf16 a[48:51], v[204:207], a[188:191], a[48:51]
ds_read_b128 a[168:171], v6 offset:16384
ds_read_b128 a[172:175], v7 offset:16384
v_mfma_f32_16x16x32_bf16 a[52:55], v[220:223], a[188:191], a[52:55]
v_exp_f32 v34, v34
v_mfma_f32_16x16x32_bf16 a[52:55], v[216:219], a[184:187], a[52:55]
buffer_load_dwordx4 v99, s[12:15], s24 offen offset:2048 lds
v_mfma_f32_16x16x32_bf16 a[52:55], v[212:215], a[180:183], a[52:55]
v_exp_f32 v35, v35
v_mfma_f32_16x16x32_bf16 a[52:55], v[208:211], a[176:179], a[52:55]
v_cvt_pk_bf16_f32 v181, v30, v31
v_cvt_pk_bf16_f32 v134, v32, v33
v_mfma_f32_16x16x32_bf16 a[56:59], v[224:227], a[176:179], a[56:59]
v_exp_f32 v36, v36
v_mfma_f32_16x16x32_bf16 a[56:59], v[228:231], a[180:183], a[56:59]
v_cvt_pk_bf16_f32 v135, v34, v35
v_mfma_f32_16x16x32_bf16 a[56:59], v[232:235], a[184:187], a[56:59]
v_exp_f32 v37, v37
v_mfma_f32_16x16x32_bf16 a[56:59], v[236:239], a[188:191], a[56:59]
buffer_load_dwordx4 v99, s[12:15], s24 offen offset:3072 lds
v_mfma_f32_16x16x32_bf16 a[60:63], v[252:255], a[188:191], a[60:63]
v_exp_f32 v38, v38
v_mfma_f32_16x16x32_bf16 a[60:63], v[248:251], a[184:187], a[60:63]
v_cvt_pk_bf16_f32 v150, v36, v37
s_add_u32 s24, s24, 32768
v_mfma_f32_16x16x32_bf16 a[60:63], v[244:247], a[180:183], a[60:63]
v_exp_f32 v39, v39
v_mfma_f32_16x16x32_bf16 a[60:63], v[240:243], a[176:179], a[60:63]
v_cvt_pk_bf16_f32 v151, v38, v39
s_add_u32 s57, s57, 32768
v_smfmac_f32_16x16x64_bf16 a[228:231], a[240:243], v[208:215], v127
v_smfmac_f32_16x16x64_bf16 a[228:231], a[240:243], v[216:223], v127
s_waitcnt lgkmcnt(0)
v_mfma_f32_16x16x32_bf16 v[16:19], a[160:163], a[128:131], v[48:51]
v_exp_f32 v40, v40
v_mfma_f32_16x16x32_bf16 v[16:19], a[164:167], a[132:135], v[16:19]
ds_read_b64_tr_b16 a[176:177], v12 offset:32768
ds_read_b64_tr_b16 a[178:179], v12 offset:33792
v_mfma_f32_16x16x32_bf16 v[16:19], a[168:171], a[136:139], v[16:19]
v_exp_f32 v41, v41
v_mfma_f32_16x16x32_bf16 v[16:19], a[172:175], a[140:143], v[16:19]
ds_read_b64_tr_b16 a[180:181], v12 offset:34816
ds_read_b64_tr_b16 a[182:183], v12 offset:35840
v_mfma_f32_16x16x32_bf16 v[20:23], a[172:175], a[156:159], v[52:55]
v_exp_f32 v42, v42
v_mfma_f32_16x16x32_bf16 v[20:23], a[168:171], a[152:155], v[20:23]
ds_read_b64_tr_b16 a[184:185], v12 offset:49152
ds_read_b64_tr_b16 a[186:187], v12 offset:50176
v_mfma_f32_16x16x32_bf16 v[20:23], a[164:167], a[148:151], v[20:23]
v_exp_f32 v43, v43
v_mfma_f32_16x16x32_bf16 v[20:23], a[160:163], a[144:147], v[20:23]
ds_read_b64_tr_b16 a[188:189], v12 offset:51200
ds_read_b64_tr_b16 a[190:191], v12 offset:52224
v_mfma_f32_16x16x32_bf16 v[24:27], a[160:163], v[64:67], v[56:59]
v_exp_f32 v44, v44
v_mfma_f32_16x16x32_bf16 v[24:27], a[164:167], v[68:71], v[24:27]
v_cvt_pk_bf16_f32 v166, v40, v41
v_cvt_pk_bf16_f32 v167, v42, v43
v_mfma_f32_16x16x32_bf16 v[24:27], a[168:171], v[72:75], v[24:27]
v_exp_f32 v45, v45
v_mfma_f32_16x16x32_bf16 v[24:27], a[172:175], v[76:79], v[24:27]
v_cvt_pk_bf16_f32 v182, v44, v45
v_mfma_f32_16x16x32_bf16 v[28:31], a[172:175], v[92:95], v[60:63]
v_exp_f32 v46, v46
v_mfma_f32_16x16x32_bf16 v[28:31], a[168:171], v[88:91], v[28:31]
v_mfma_f32_16x16x32_bf16 v[28:31], a[164:167], v[84:87], v[28:31]
v_exp_f32 v47, v47
v_mfma_f32_16x16x32_bf16 v[28:31], a[160:163], v[80:83], v[28:31]
v_cvt_pk_bf16_f32 v183, v46, v47
s_waitcnt lgkmcnt(0)
v_mfma_f32_16x16x32_bf16 a[64:67], v[192:195], a[176:179], a[64:67]
v_exp_f32 v16, v16
v_mfma_f32_16x16x32_bf16 a[64:67], v[196:199], a[180:183], a[64:67]
ds_read_b128 a[160:163], v4 offset:17408
ds_read_b128 a[164:167], v5 offset:17408
v_mfma_f32_16x16x32_bf16 a[64:67], v[200:203], a[184:187], a[64:67]
v_exp_f32 v17, v17
v_mfma_f32_16x16x32_bf16 a[64:67], v[204:207], a[188:191], a[64:67]
ds_read_b128 a[168:171], v6 offset:17408
ds_read_b128 a[172:175], v7 offset:17408
v_mfma_f32_16x16x32_bf16 a[68:71], v[220:223], a[188:191], a[68:71]
v_exp_f32 v18, v18
v_mfma_f32_16x16x32_bf16 a[68:71], v[216:219], a[184:187], a[68:71]
v_cvt_pk_bf16_f32 v136, v16, v17
v_mfma_f32_16x16x32_bf16 a[68:71], v[212:215], a[180:183], a[68:71]
v_exp_f32 v19, v19
v_mfma_f32_16x16x32_bf16 a[68:71], v[208:211], a[176:179], a[68:71]
v_cvt_pk_bf16_f32 v137, v18, v19
v_mfma_f32_16x16x32_bf16 a[72:75], v[224:227], a[176:179], a[72:75]
v_exp_f32 v20, v20
v_mfma_f32_16x16x32_bf16 a[72:75], v[228:231], a[180:183], a[72:75]
v_mfma_f32_16x16x32_bf16 a[72:75], v[232:235], a[184:187], a[72:75]
v_exp_f32 v21, v21
v_mfma_f32_16x16x32_bf16 a[72:75], v[236:239], a[188:191], a[72:75]
v_cvt_pk_bf16_f32 v152, v20, v21
v_mfma_f32_16x16x32_bf16 a[76:79], v[252:255], a[188:191], a[76:79]
v_exp_f32 v22, v22
v_mfma_f32_16x16x32_bf16 a[76:79], v[248:251], a[184:187], a[76:79]
v_mfma_f32_16x16x32_bf16 a[76:79], v[244:247], a[180:183], a[76:79]
v_exp_f32 v23, v23
v_mfma_f32_16x16x32_bf16 a[76:79], v[240:243], a[176:179], a[76:79]
v_cvt_pk_bf16_f32 v153, v22, v23
s_waitcnt lgkmcnt(0)
v_mfma_f32_16x16x32_bf16 v[32:35], a[160:163], a[128:131], v[48:51]
v_exp_f32 v24, v24
v_mfma_f32_16x16x32_bf16 v[32:35], a[164:167], a[132:135], v[32:35]
ds_read_b64_tr_b16 a[176:177], v13 offset:32768
ds_read_b64_tr_b16 a[178:179], v13 offset:33792
v_mfma_f32_16x16x32_bf16 v[32:35], a[168:171], a[136:139], v[32:35]
v_exp_f32 v25, v25
v_mfma_f32_16x16x32_bf16 v[32:35], a[172:175], a[140:143], v[32:35]
ds_read_b64_tr_b16 a[180:181], v13 offset:34816
ds_read_b64_tr_b16 a[182:183], v13 offset:35840
v_mfma_f32_16x16x32_bf16 v[36:39], a[172:175], a[156:159], v[52:55]
v_exp_f32 v26, v26
v_mfma_f32_16x16x32_bf16 v[36:39], a[168:171], a[152:155], v[36:39]
ds_read_b64_tr_b16 a[184:185], v13 offset:49152
ds_read_b64_tr_b16 a[186:187], v13 offset:50176
v_mfma_f32_16x16x32_bf16 v[36:39], a[164:167], a[148:151], v[36:39]
v_exp_f32 v27, v27
v_mfma_f32_16x16x32_bf16 v[36:39], a[160:163], a[144:147], v[36:39]
ds_read_b64_tr_b16 a[188:189], v13 offset:51200
ds_read_b64_tr_b16 a[190:191], v13 offset:52224
v_mfma_f32_16x16x32_bf16 v[40:43], a[160:163], v[64:67], v[56:59]
v_exp_f32 v28, v28
v_mfma_f32_16x16x32_bf16 v[40:43], a[164:167], v[68:71], v[40:43]
v_cvt_pk_bf16_f32 v168, v24, v25
v_cvt_pk_bf16_f32 v169, v26, v27
v_mfma_f32_16x16x32_bf16 v[40:43], a[168:171], v[72:75], v[40:43]
v_exp_f32 v29, v29
v_mfma_f32_16x16x32_bf16 v[40:43], a[172:175], v[76:79], v[40:43]
v_cvt_pk_bf16_f32 v184, v28, v29
v_mfma_f32_16x16x32_bf16 v[44:47], a[172:175], v[92:95], v[60:63]
v_exp_f32 v30, v30
v_mfma_f32_16x16x32_bf16 v[44:47], a[168:171], v[88:91], v[44:47]
v_mfma_f32_16x16x32_bf16 v[44:47], a[164:167], v[84:87], v[44:47]
v_exp_f32 v31, v31
v_mfma_f32_16x16x32_bf16 v[44:47], a[160:163], v[80:83], v[44:47]
v_cvt_pk_bf16_f32 v185, v30, v31
s_waitcnt lgkmcnt(0)
v_mfma_f32_16x16x32_bf16 a[80:83], v[192:195], a[176:179], a[80:83]
v_exp_f32 v32, v32
v_mfma_f32_16x16x32_bf16 a[80:83], v[196:199], a[180:183], a[80:83]
ds_read_b128 a[160:163], v4 offset:18432
ds_read_b128 a[164:167], v5 offset:18432
v_mfma_f32_16x16x32_bf16 a[80:83], v[200:203], a[184:187], a[80:83]
v_exp_f32 v33, v33
v_mfma_f32_16x16x32_bf16 a[80:83], v[204:207], a[188:191], a[80:83]
ds_read_b128 a[168:171], v6 offset:18432
ds_read_b128 a[172:175], v7 offset:18432
v_mfma_f32_16x16x32_bf16 a[84:87], v[220:223], a[188:191], a[84:87]
v_exp_f32 v34, v34
v_mfma_f32_16x16x32_bf16 a[84:87], v[216:219], a[184:187], a[84:87]
v_cvt_pk_bf16_f32 v138, v32, v33
v_mfma_f32_16x16x32_bf16 a[84:87], v[212:215], a[180:183], a[84:87]
v_exp_f32 v35, v35
v_mfma_f32_16x16x32_bf16 a[84:87], v[208:211], a[176:179], a[84:87]
v_cvt_pk_bf16_f32 v139, v34, v35
v_mfma_f32_16x16x32_bf16 a[88:91], v[224:227], a[176:179], a[88:91]
v_exp_f32 v36, v36
v_mfma_f32_16x16x32_bf16 a[88:91], v[228:231], a[180:183], a[88:91]
v_mfma_f32_16x16x32_bf16 a[88:91], v[232:235], a[184:187], a[88:91]
v_exp_f32 v37, v37
v_mfma_f32_16x16x32_bf16 a[88:91], v[236:239], a[188:191], a[88:91]
v_cvt_pk_bf16_f32 v154, v36, v37
v_mfma_f32_16x16x32_bf16 a[92:95], v[252:255], a[188:191], a[92:95]
v_exp_f32 v38, v38
v_mfma_f32_16x16x32_bf16 a[92:95], v[248:251], a[184:187], a[92:95]
v_mfma_f32_16x16x32_bf16 a[92:95], v[244:247], a[180:183], a[92:95]
v_exp_f32 v39, v39
v_mfma_f32_16x16x32_bf16 a[92:95], v[240:243], a[176:179], a[92:95]
v_cvt_pk_bf16_f32 v155, v38, v39
v_smfmac_f32_16x16x64_bf16 a[232:235], a[240:243], v[224:231], v127
v_smfmac_f32_16x16x64_bf16 a[232:235], a[240:243], v[232:239], v127
s_waitcnt lgkmcnt(0)
v_mfma_f32_16x16x32_bf16 v[16:19], a[160:163], a[128:131], v[48:51]
v_exp_f32 v40, v40
v_mfma_f32_16x16x32_bf16 v[16:19], a[164:167], a[132:135], v[16:19]
ds_read_b64_tr_b16 a[176:177], v14 offset:32768
ds_read_b64_tr_b16 a[178:179], v14 offset:33792
v_mfma_f32_16x16x32_bf16 v[16:19], a[168:171], a[136:139], v[16:19]
v_exp_f32 v41, v41
v_mfma_f32_16x16x32_bf16 v[16:19], a[172:175], a[140:143], v[16:19]
ds_read_b64_tr_b16 a[180:181], v14 offset:34816
ds_read_b64_tr_b16 a[182:183], v14 offset:35840
v_mfma_f32_16x16x32_bf16 v[20:23], a[172:175], a[156:159], v[52:55]
v_exp_f32 v42, v42
v_mfma_f32_16x16x32_bf16 v[20:23], a[168:171], a[152:155], v[20:23]
ds_read_b64_tr_b16 a[184:185], v14 offset:49152
ds_read_b64_tr_b16 a[186:187], v14 offset:50176
v_mfma_f32_16x16x32_bf16 v[20:23], a[164:167], a[148:151], v[20:23]
v_exp_f32 v43, v43
v_mfma_f32_16x16x32_bf16 v[20:23], a[160:163], a[144:147], v[20:23]
ds_read_b64_tr_b16 a[188:189], v14 offset:51200
ds_read_b64_tr_b16 a[190:191], v14 offset:52224
v_mfma_f32_16x16x32_bf16 v[24:27], a[160:163], v[64:67], v[56:59]
v_exp_f32 v44, v44
v_mfma_f32_16x16x32_bf16 v[24:27], a[164:167], v[68:71], v[24:27]
v_cvt_pk_bf16_f32 v170, v40, v41
v_cvt_pk_bf16_f32 v171, v42, v43
v_mfma_f32_16x16x32_bf16 v[24:27], a[168:171], v[72:75], v[24:27]
v_exp_f32 v45, v45
v_mfma_f32_16x16x32_bf16 v[24:27], a[172:175], v[76:79], v[24:27]
v_cvt_pk_bf16_f32 v186, v44, v45
v_mfma_f32_16x16x32_bf16 v[28:31], a[172:175], v[92:95], v[60:63]
v_exp_f32 v46, v46
v_mfma_f32_16x16x32_bf16 v[28:31], a[168:171], v[88:91], v[28:31]
v_mfma_f32_16x16x32_bf16 v[28:31], a[164:167], v[84:87], v[28:31]
v_exp_f32 v47, v47
v_mfma_f32_16x16x32_bf16 v[28:31], a[160:163], v[80:83], v[28:31]
v_cvt_pk_bf16_f32 v187, v46, v47
s_waitcnt lgkmcnt(0)
v_mfma_f32_16x16x32_bf16 a[96:99], v[192:195], a[176:179], a[96:99]
v_exp_f32 v16, v16
v_mfma_f32_16x16x32_bf16 a[96:99], v[196:199], a[180:183], a[96:99]
ds_read_b128 a[160:163], v4 offset:19456
ds_read_b128 a[164:167], v5 offset:19456
v_mfma_f32_16x16x32_bf16 a[96:99], v[200:203], a[184:187], a[96:99]
v_exp_f32 v17, v17
v_mfma_f32_16x16x32_bf16 a[96:99], v[204:207], a[188:191], a[96:99]
ds_read_b128 a[168:171], v6 offset:19456
ds_read_b128 a[172:175], v7 offset:19456
v_mfma_f32_16x16x32_bf16 a[100:103], v[220:223], a[188:191], a[100:103]
v_exp_f32 v18, v18
v_mfma_f32_16x16x32_bf16 a[100:103], v[216:219], a[184:187], a[100:103]
v_cvt_pk_bf16_f32 v140, v16, v17
v_mfma_f32_16x16x32_bf16 a[100:103], v[212:215], a[180:183], a[100:103]
v_exp_f32 v19, v19
v_mfma_f32_16x16x32_bf16 a[100:103], v[208:211], a[176:179], a[100:103]
v_cvt_pk_bf16_f32 v141, v18, v19
v_mfma_f32_16x16x32_bf16 a[104:107], v[224:227], a[176:179], a[104:107]
v_exp_f32 v20, v20
v_mfma_f32_16x16x32_bf16 a[104:107], v[228:231], a[180:183], a[104:107]
v_mfma_f32_16x16x32_bf16 a[104:107], v[232:235], a[184:187], a[104:107]
v_exp_f32 v21, v21
v_mfma_f32_16x16x32_bf16 a[104:107], v[236:239], a[188:191], a[104:107]
v_cvt_pk_bf16_f32 v156, v20, v21
v_mfma_f32_16x16x32_bf16 a[108:111], v[252:255], a[188:191], a[108:111]
v_exp_f32 v22, v22
v_mfma_f32_16x16x32_bf16 a[108:111], v[248:251], a[184:187], a[108:111]
v_mfma_f32_16x16x32_bf16 a[108:111], v[244:247], a[180:183], a[108:111]
v_exp_f32 v23, v23
v_mfma_f32_16x16x32_bf16 a[108:111], v[240:243], a[176:179], a[108:111]
v_cvt_pk_bf16_f32 v157, v22, v23
s_waitcnt lgkmcnt(0)
v_mfma_f32_16x16x32_bf16 v[32:35], a[160:163], a[128:131], v[48:51]
v_exp_f32 v24, v24
v_mfma_f32_16x16x32_bf16 v[32:35], a[164:167], a[132:135], v[32:35]
ds_read_b64_tr_b16 a[176:177], v15 offset:32768
ds_read_b64_tr_b16 a[178:179], v15 offset:33792
v_mfma_f32_16x16x32_bf16 v[32:35], a[168:171], a[136:139], v[32:35]
v_exp_f32 v25, v25
v_mfma_f32_16x16x32_bf16 v[32:35], a[172:175], a[140:143], v[32:35]
ds_read_b64_tr_b16 a[180:181], v15 offset:34816
ds_read_b64_tr_b16 a[182:183], v15 offset:35840
v_mfma_f32_16x16x32_bf16 v[36:39], a[172:175], a[156:159], v[52:55]
v_exp_f32 v26, v26
v_mfma_f32_16x16x32_bf16 v[36:39], a[168:171], a[152:155], v[36:39]
ds_read_b64_tr_b16 a[184:185], v15 offset:49152
ds_read_b64_tr_b16 a[186:187], v15 offset:50176
v_mfma_f32_16x16x32_bf16 v[36:39], a[164:167], a[148:151], v[36:39]
v_exp_f32 v27, v27
v_mfma_f32_16x16x32_bf16 v[36:39], a[160:163], a[144:147], v[36:39]
ds_read_b64_tr_b16 a[188:189], v15 offset:51200
ds_read_b64_tr_b16 a[190:191], v15 offset:52224
v_mfma_f32_16x16x32_bf16 v[40:43], a[160:163], v[64:67], v[56:59]
v_exp_f32 v28, v28
v_mfma_f32_16x16x32_bf16 v[40:43], a[164:167], v[68:71], v[40:43]
v_cvt_pk_bf16_f32 v172, v24, v25
v_cvt_pk_bf16_f32 v173, v26, v27
v_mfma_f32_16x16x32_bf16 v[40:43], a[168:171], v[72:75], v[40:43]
v_exp_f32 v29, v29
v_mfma_f32_16x16x32_bf16 v[40:43], a[172:175], v[76:79], v[40:43]
v_cvt_pk_bf16_f32 v188, v28, v29
v_mfma_f32_16x16x32_bf16 v[44:47], a[172:175], v[92:95], v[60:63]
v_exp_f32 v30, v30
v_mfma_f32_16x16x32_bf16 v[44:47], a[168:171], v[88:91], v[44:47]
v_mfma_f32_16x16x32_bf16 v[44:47], a[164:167], v[84:87], v[44:47]
v_exp_f32 v31, v31
v_mfma_f32_16x16x32_bf16 v[44:47], a[160:163], v[80:83], v[44:47]
s_waitcnt vmcnt(0) lgkmcnt(0)
s_barrier
v_mfma_f32_16x16x32_bf16 a[112:115], v[192:195], a[176:179], a[112:115]
v_exp_f32 v32, v32
v_mfma_f32_16x16x32_bf16 a[112:115], v[196:199], a[180:183], a[112:115]
ds_read_b128 a[160:163], v4 offset:32768
ds_read_b128 a[164:167], v5 offset:32768
v_mfma_f32_16x16x32_bf16 a[112:115], v[200:203], a[184:187], a[112:115]
v_exp_f32 v33, v33
v_mfma_f32_16x16x32_bf16 a[112:115], v[204:207], a[188:191], a[112:115]
ds_read_b128 a[168:171], v6 offset:32768
ds_read_b128 a[172:175], v7 offset:32768
v_mfma_f32_16x16x32_bf16 a[116:119], v[220:223], a[188:191], a[116:119]
v_exp_f32 v34, v34
v_mfma_f32_16x16x32_bf16 a[116:119], v[216:219], a[184:187], a[116:119]
v_cvt_pk_bf16_f32 v189, v30, v31
v_cvt_pk_bf16_f32 v142, v32, v33
v_mfma_f32_16x16x32_bf16 a[116:119], v[212:215], a[180:183], a[116:119]
v_exp_f32 v35, v35
v_mfma_f32_16x16x32_bf16 a[116:119], v[208:211], a[176:179], a[116:119]
v_cvt_pk_bf16_f32 v143, v34, v35
s_cmp_lg_u32 s24, s59
v_mfma_f32_16x16x32_bf16 a[120:123], v[224:227], a[176:179], a[120:123]
v_exp_f32 v36, v36
v_mfma_f32_16x16x32_bf16 a[120:123], v[228:231], a[180:183], a[120:123]
v_mfma_f32_16x16x32_bf16 a[120:123], v[232:235], a[184:187], a[120:123]
v_exp_f32 v37, v37
v_mfma_f32_16x16x32_bf16 a[120:123], v[236:239], a[188:191], a[120:123]
v_cvt_pk_bf16_f32 v158, v36, v37
v_mfma_f32_16x16x32_bf16 a[124:127], v[252:255], a[188:191], a[124:127]
v_exp_f32 v38, v38
v_mfma_f32_16x16x32_bf16 a[124:127], v[248:251], a[184:187], a[124:127]
v_mfma_f32_16x16x32_bf16 a[124:127], v[244:247], a[180:183], a[124:127]
v_exp_f32 v39, v39
v_mfma_f32_16x16x32_bf16 a[124:127], v[240:243], a[176:179], a[124:127]
v_cvt_pk_bf16_f32 v159, v38, v39
v_smfmac_f32_16x16x64_bf16 a[236:239], a[240:243], v[240:247], v127
v_smfmac_f32_16x16x64_bf16 a[236:239], a[240:243], v[248:255], v127
s_waitcnt lgkmcnt(0)
s_cbranch_scc1 L_loop
s_cmp_lg_u32 s24, 491520
s_cbranch_scc1 L_touch
L_final:
v_mfma_f32_16x16x32_bf16 v[16:19], a[160:163], a[128:131], v[48:51]
v_exp_f32 v40, v40
v_mfma_f32_16x16x32_bf16 v[16:19], a[164:167], a[132:135], v[16:19]
v_exp_f32 v41, v41
v_mfma_f32_16x16x32_bf16 v[16:19], a[168:171], a[136:139], v[16:19]
ds_read_b64_tr_b16 a[176:177], v8 offset:0
v_exp_f32 v42, v42
v_mfma_f32_16x16x32_bf16 v[16:19], a[172:175], a[140:143], v[16:19]
v_exp_f32 v43, v43
v_mfma_f32_16x16x32_bf16 v[20:23], a[172:175], a[156:159], v[52:55]
ds_read_b64_tr_b16 a[178:179], v8 offset:1024
v_exp_f32 v44, v44
v_mfma_f32_16x16x32_bf16 v[20:23], a[168:171], a[152:155], v[20:23]
ds_read_b64_tr_b16 a[180:181], v8 offset:2048
ds_read_b64_tr_b16 a[182:183], v8 offset:3072
v_mfma_f32_16x16x32_bf16 v[20:23], a[164:167], a[148:151], v[20:23]
ds_read_b64_tr_b16 a[184:185], v8 offset:16384
ds_read_b64_tr_b16 a[186:187], v8 offset:17408
ds_read_b64_tr_b16 a[188:189], v8 offset:18432
v_mfma_f32_16x16x32_bf16 v[20:23], a[160:163], a[144:147], v[20:23]
ds_read_b64_tr_b16 a[190:191], v8 offset:19456
s_add_u32 m0, s25, 98304
v_mfma_f32_16x16x32_bf16 v[24:27], a[160:163], v[64:67], v[56:59]
v_exp_f32 v45, v45
v_mfma_f32_16x16x32_bf16 v[24:27], a[164:167], v[68:71], v[24:27]
v_exp_f32 v46, v46
v_mfma_f32_16x16x32_bf16 v[24:27], a[168:171], v[72:75], v[24:27]
v_exp_f32 v47, v47
v_mfma_f32_16x16x32_bf16 v[24:27], a[172:175], v[76:79], v[24:27]
v_exp_f32 v16, v16
v_mfma_f32_16x16x32_bf16 v[28:31], a[172:175], v[92:95], v[60:63]
buffer_load_dwordx4 v98, s[12:15], s24 offen offset:0 lds
v_mfma_f32_16x16x32_bf16 v[28:31], a[168:171], v[88:91], v[28:31]
v_exp_f32 v17, v17
v_mfma_f32_16x16x32_bf16 v[28:31], a[164:167], v[84:87], v[28:31]
v_exp_f32 v18, v18
v_mfma_f32_16x16x32_bf16 v[28:31], a[160:163], v[80:83], v[28:31]
v_cvt_pk_bf16_f32 v174, v40, v41
s_waitcnt lgkmcnt(0)
v_mfma_f32_16x16x32_bf16 a[0:3], v[128:131], a[176:179], a[0:3]
v_exp_f32 v19, v19
v_mfma_f32_16x16x32_bf16 a[0:3], v[132:135], a[180:183], a[0:3]
v_cvt_pk_bf16_f32 v175, v42, v43
v_exp_f32 v20, v20
v_mfma_f32_16x16x32_bf16 a[0:3], v[136:139], a[184:187], a[0:3]
v_exp_f32 v21, v21
v_mfma_f32_16x16x32_bf16 a[0:3], v[140:143], a[188:191], a[0:3]
buffer_load_dwordx4 v98, s[12:15], s24 offen offset:1024 lds
v_mfma_f32_16x16x32_bf16 a[4:7], v[156:159], a[188:191], a[4:7]
v_exp_f32 v22, v22
v_mfma_f32_16x16x32_bf16 a[4:7], v[152:155], a[184:187], a[4:7]
v_exp_f32 v23, v23
v_mfma_f32_16x16x32_bf16 a[4:7], v[148:151], a[180:183], a[4:7]
ds_read_b128 a[192:195], v4 offset:33792
ds_read_b128 a[196:199], v5 offset:33792
v_mfma_f32_16x16x32_bf16 a[4:7], v[144:147], a[176:179], a[4:7]
ds_read_b128 a[200:203], v6 offset:33792
ds_read_b128 a[204:207], v7 offset:33792
v_mfma_f32_16x16x32_bf16 a[8:11], v[160:163], a[176:179], a[8:11]
v_exp_f32 v24, v24
v_mfma_f32_16x16x32_bf16 a[8:11], v[164:167], a[180:183], a[8:11]
v_exp_f32 v25, v25
v_mfma_f32_16x16x32_bf16 a[8:11], v[168:171], a[184:187], a[8:11]
v_cvt_pk_bf16_f32 v190, v44, v45
v_cvt_pk_bf16_f32 v191, v46, v47
v_cvt_pk_bf16_f32 v192, v16, v17
v_mfma_f32_16x16x32_bf16 a[8:11], v[172:175], a[188:191], a[8:11]
v_exp_f32 v26, v26
v_mfma_f32_16x16x32_bf16 a[12:15], v[188:191], a[188:191], a[12:15]
v_exp_f32 v27, v27
v_mfma_f32_16x16x32_bf16 a[12:15], v[184:187], a[184:187], a[12:15]
buffer_load_dwordx4 v98, s[12:15], s24 offen offset:2048 lds
v_mfma_f32_16x16x32_bf16 a[12:15], v[180:183], a[180:183], a[12:15]
v_cvt_pk_bf16_f32 v193, v18, v19
v_exp_f32 v28, v28
v_mfma_f32_16x16x32_bf16 a[12:15], v[176:179], a[176:179], a[12:15]
v_exp_f32 v29, v29
s_waitcnt lgkmcnt(0)
v_mfma_f32_16x16x32_bf16 v[32:35], a[192:195], a[128:131], v[48:51]
v_exp_f32 v30, v30
v_mfma_f32_16x16x32_bf16 v[32:35], a[196:199], a[132:135], v[32:35]
v_exp_f32 v31, v31
v_mfma_f32_16x16x32_bf16 v[32:35], a[200:203], a[136:139], v[32:35]
buffer_load_dwordx4 v98, s[12:15], s24 offen offset:3072 lds
v_mfma_f32_16x16x32_bf16 v[32:35], a[204:207], a[140:143], v[32:35]
ds_read_b128 a[160:163], v4 offset:34816
s_add_u32 m0, s25, 114688
v_mfma_f32_16x16x32_bf16 v[36:39], a[204:207], a[156:159], v[52:55]
ds_read_b128 a[164:167], v5 offset:34816
ds_read_b128 a[168:171], v6 offset:34816
v_mfma_f32_16x16x32_bf16 v[36:39], a[200:203], a[152:155], v[36:39]
ds_read_b128 a[172:175], v7 offset:34816
v_cvt_pk_bf16_f32 v208, v20, v21
v_mfma_f32_16x16x32_bf16 v[36:39], a[196:199], a[148:151], v[36:39]
buffer_load_dwordx4 v99, s[12:15], s24 offen offset:0 lds
v_mfma_f32_16x16x32_bf16 v[36:39], a[192:195], a[144:147], v[36:39]
v_exp_f32 v32, v32
v_mfma_f32_16x16x32_bf16 v[40:43], a[192:195], v[64:67], v[56:59]
v_exp_f32 v33, v33
v_mfma_f32_16x16x32_bf16 v[40:43], a[196:199], v[68:71], v[40:43]
v_exp_f32 v34, v34
v_mfma_f32_16x16x32_bf16 v[40:43], a[200:203], v[72:75], v[40:43]
v_exp_f32 v35, v35
v_mfma_f32_16x16x32_bf16 v[40:43], a[204:207], v[76:79], v[40:43]
v_exp_f32 v36, v36
v_mfma_f32_16x16x32_bf16 v[44:47], a[204:207], v[92:95], v[60:63]
v_exp_f32 v37, v37
v_mfma_f32_16x16x32_bf16 v[44:47], a[200:203], v[88:91], v[44:47]
v_exp_f32 v38, v38
v_mfma_f32_16x16x32_bf16 v[44:47], a[196:199], v[84:87], v[44:47]
v_exp_f32 v39, v39
v_mfma_f32_16x16x32_bf16 v[44:47], a[192:195], v[80:83], v[44:47]
v_exp_f32 v40, v40
v_smfmac_f32_16x16x64_bf16 a[224:227], a[240:243], v[128:135], v127
v_exp_f32 v41, v41
v_smfmac_f32_16x16x64_bf16 a[224:227], a[240:243], v[136:143], v127
v_cvt_pk_bf16_f32 v209, v22, v23
v_exp_f32 v42, v42
v_smfmac_f32_16x16x64_bf16 a[228:231], a[240:243], v[144:151], v127
v_exp_f32 v43, v43
v_smfmac_f32_16x16x64_bf16 a[228:231], a[240:243], v[152:159], v127
v_cvt_pk_bf16_f32 v224, v24, v25
s_waitcnt lgkmcnt(0)
v_mfma_f32_16x16x32_bf16 v[16:19], a[160:163], a[128:131], v[48:51]
v_exp_f32 v44, v44
v_mfma_f32_16x16x32_bf16 v[16:19], a[164:167], a[132:135], v[16:19]
v_exp_f32 v45, v45
v_mfma_f32_16x16x32_bf16 v[16:19], a[168:171], a[136:139], v[16:19]
ds_read_b128 a[192:195], v4 offset:35840
buffer_load_dwordx4 v99, s[12:15], s24 offen offset:1024 lds
v_mfma_f32_16x16x32_bf16 v[16:19], a[172:175], a[140:143], v[16:19]
v_exp_f32 v46, v46
v_mfma_f32_16x16x32_bf16 v[20:23], a[172:175], a[156:159], v[52:55]
v_exp_f32 v47, v47
v_mfma_f32_16x16x32_bf16 v[20:23], a[168:171], a[152:155], v[20:23]
ds_read_b128 a[196:199], v5 offset:35840
ds_read_b128 a[200:203], v6 offset:35840
v_mfma_f32_16x16x32_bf16 v[20:23], a[164:167], a[148:151], v[20:23]
ds_read_b128 a[204:207], v7 offset:35840
v_cvt_pk_bf16_f32 v225, v26, v27
v_cvt_pk_bf16_f32 v240, v28, v29
v_mfma_f32_16x16x32_bf16 v[20:23], a[160:163], a[144:147], v[20:23]
v_exp_f32 v16, v16
v_mfma_f32_16x16x32_bf16 v[24:27], a[160:163], v[64:67], v[56:59]
v_cvt_pk_bf16_f32 v241, v30, v31
v_exp_f32 v17, v17
v_mfma_f32_16x16x32_bf16 v[24:27], a[164:167], v[68:71], v[24:27]
v_cvt_pk_bf16_f32 v194, v32, v33
v_exp_f32 v18, v18
v_mfma_f32_16x16x32_bf16 v[24:27], a[168:171], v[72:75], v[24:27]
v_exp_f32 v19, v19
v_mfma_f32_16x16x32_bf16 v[24:27], a[172:175], v[76:79], v[24:27]
buffer_load_dwordx4 v99, s[12:15], s24 offen offset:2048 lds
v_cvt_pk_bf16_f32 v195, v34, v35
v_mfma_f32_16x16x32_bf16 v[28:31], a[172:175], v[92:95], v[60:63]
v_exp_f32 v20, v20
v_mfma_f32_16x16x32_bf16 v[28:31], a[168:171], v[88:91], v[28:31]
v_cvt_pk_bf16_f32 v210, v36, v37
v_exp_f32 v21, v21
v_mfma_f32_16x16x32_bf16 v[28:31], a[164:167], v[84:87], v[28:31]
v_cvt_pk_bf16_f32 v211, v38, v39
v_exp_f32 v22, v22
v_mfma_f32_16x16x32_bf16 v[28:31], a[160:163], v[80:83], v[28:31]
ds_read_b64_tr_b16 a[208:209], v9 offset:0
s_waitcnt lgkmcnt(1)
v_mfma_f32_16x16x32_bf16 v[32:35], a[192:195], a[128:131], v[48:51]
ds_read_b64_tr_b16 a[210:211], v9 offset:1024
v_exp_f32 v23, v23
v_mfma_f32_16x16x32_bf16 v[32:35], a[196:199], a[132:135], v[32:35]
v_exp_f32 v24, v24
v_mfma_f32_16x16x32_bf16 v[32:35], a[200:203], a[136:139], v[32:35]
ds_read_b64_tr_b16 a[212:213], v9 offset:2048
v_exp_f32 v25, v25
v_mfma_f32_16x16x32_bf16 v[32:35], a[204:207], a[140:143], v[32:35]
ds_read_b64_tr_b16 a[214:215], v9 offset:3072
v_exp_f32 v26, v26
v_mfma_f32_16x16x32_bf16 v[36:39], a[204:207], a[156:159], v[52:55]
buffer_load_dwordx4 v99, s[12:15], s24 offen offset:3072 lds
v_mfma_f32_16x16x32_bf16 v[36:39], a[200:203], a[152:155], v[36:39]
ds_read_b64_tr_b16 a[216:217], v9 offset:16384
ds_read_b64_tr_b16 a[218:219], v9 offset:17408
ds_read_b64_tr_b16 a[220:221], v9 offset:18432
v_mfma_f32_16x16x32_bf16 v[36:39], a[196:199], a[148:151], v[36:39]
ds_read_b64_tr_b16 a[222:223], v9 offset:19456
v_cvt_pk_bf16_f32 v226, v40, v41
v_mfma_f32_16x16x32_bf16 v[36:39], a[192:195], a[144:147], v[36:39]
v_cvt_pk_bf16_f32 v227, v42, v43
v_exp_f32 v27, v27
v_mfma_f32_16x16x32_bf16 v[40:43], a[192:195], v[64:67], v[56:59]
v_exp_f32 v28, v28
v_mfma_f32_16x16x32_bf16 v[40:43], a[196:199], v[68:71], v[40:43]
v_exp_f32 v29, v29
v_mfma_f32_16x16x32_bf16 v[40:43], a[200:203], v[72:75], v[40:43]
v_cvt_pk_bf16_f32 v242, v44, v45
v_cvt_pk_bf16_f32 v243, v46, v47
v_mfma_f32_16x16x32_bf16 v[40:43], a[204:207], v[76:79], v[40:43]
v_exp_f32 v30, v30
v_mfma_f32_16x16x32_bf16 v[44:47], a[204:207], v[92:95], v[60:63]
v_exp_f32 v31, v31
v_mfma_f32_16x16x32_bf16 v[44:47], a[200:203], v[88:91], v[44:47]
v_exp_f32 v32, v32
v_mfma_f32_16x16x32_bf16 v[44:47], a[196:199], v[84:87], v[44:47]
v_exp_f32 v33, v33
v_mfma_f32_16x16x32_bf16 v[44:47], a[192:195], v[80:83], v[44:47]
ds_read_b128 a[160:163], v4 offset:49152
s_waitcnt lgkmcnt(1)
v_mfma_f32_16x16x32_bf16 a[16:19], v[128:131], a[208:211], a[16:19]
v_exp_f32 v34, v34
v_mfma_f32_16x16x32_bf16 a[16:19], v[132:135], a[212:215], a[16:19]
v_exp_f32 v35, v35
v_mfma_f32_16x16x32_bf16 a[16:19], v[136:139], a[216:219], a[16:19]
v_exp_f32 v36, v36
v_mfma_f32_16x16x32_bf16 a[16:19], v[140:143], a[220:223], a[16:19]
v_exp_f32 v37, v37
v_mfma_f32_16x16x32_bf16 a[20:23], v[156:159], a[220:223], a[20:23]
ds_read_b128 a[164:167], v5 offset:49152
ds_read_b128 a[168:171], v6 offset:49152
v_mfma_f32_16x16x32_bf16 a[20:23], v[152:155], a[216:219], a[20:23]
ds_read_b128 a[172:175], v7 offset:49152
v_cvt_pk_bf16_f32 v196, v16, v17
v_mfma_f32_16x16x32_bf16 a[20:23], v[148:151], a[212:215], a[20:23]
v_exp_f32 v38, v38
v_mfma_f32_16x16x32_bf16 a[20:23], v[144:147], a[208:211], a[20:23]
v_exp_f32 v39, v39
v_mfma_f32_16x16x32_bf16 a[24:27], v[160:163], a[208:211], a[24:27]
v_exp_f32 v40, v40
v_mfma_f32_16x16x32_bf16 a[24:27], v[164:167], a[212:215], a[24:27]
v_exp_f32 v41, v41
v_mfma_f32_16x16x32_bf16 a[24:27], v[168:171], a[216:219], a[24:27]
v_cvt_pk_bf16_f32 v197, v18, v19
v_cvt_pk_bf16_f32 v212, v20, v21
v_mfma_f32_16x16x32_bf16 a[24:27], v[172:175], a[220:223], a[24:27]
v_exp_f32 v42, v42
v_mfma_f32_16x16x32_bf16 a[28:31], v[188:191], a[220:223], a[28:31]
v_exp_f32 v43, v43
v_mfma_f32_16x16x32_bf16 a[28:31], v[184:187], a[216:219], a[28:31]
v_cvt_pk_bf16_f32 v213, v22, v23
v_cvt_pk_bf16_f32 v228, v24, v25
v_mfma_f32_16x16x32_bf16 a[28:31], v[180:183], a[212:215], a[28:31]
v_exp_f32 v44, v44
v_mfma_f32_16x16x32_bf16 a[28:31], v[176:179], a[208:211], a[28:31]
v_cvt_pk_bf16_f32 v229, v26, v27
s_waitcnt lgkmcnt(0)
v_mfma_f32_16x16x32_bf16 v[16:19], a[160:163], a[128:131], v[48:51]
v_exp_f32 v45, v45
v_mfma_f32_16x16x32_bf16 v[16:19], a[164:167], a[132:135], v[16:19]
v_exp_f32 v46, v46
v_mfma_f32_16x16x32_bf16 v[16:19], a[168:171], a[136:139], v[16:19]
v_exp_f32 v47, v47
v_mfma_f32_16x16x32_bf16 v[16:19], a[172:175], a[140:143], v[16:19]
ds_read_b128 a[192:195], v4 offset:50176
ds_read_b128 a[196:199], v5 offset:50176
v_mfma_f32_16x16x32_bf16 v[20:23], a[172:175], a[156:159], v[52:55]
ds_read_b128 a[200:203], v6 offset:50176
ds_read_b128 a[204:207], v7 offset:50176
v_mfma_f32_16x16x32_bf16 v[20:23], a[168:171], a[152:155], v[20:23]
v_cvt_pk_bf16_f32 v244, v28, v29
v_cvt_pk_bf16_f32 v245, v30, v31
v_mfma_f32_16x16x32_bf16 v[20:23], a[164:167], a[148:151], v[20:23]
v_cvt_pk_bf16_f32 v198, v32, v33
v_cvt_pk_bf16_f32 v199, v34, v35
v_mfma_f32_16x16x32_bf16 v[20:23], a[160:163], a[144:147], v[20:23]
v_exp_f32 v16, v16
v_mfma_f32_16x16x32_bf16 v[24:27], a[160:163], v[64:67], v[56:59]
v_exp_f32 v17, v17
v_mfma_f32_16x16x32_bf16 v[24:27], a[164:167], v[68:71], v[24:27]
v_exp_f32 v18, v18
v_mfma_f32_16x16x32_bf16 v[24:27], a[168:171], v[72:75], v[24:27]
v_exp_f32 v19, v19
v_mfma_f32_16x16x32_bf16 v[24:27], a[172:175], v[76:79], v[24:27]
v_exp_f32 v20, v20
v_mfma_f32_16x16x32_bf16 v[28:31], a[172:175], v[92:95], v[60:63]
v_exp_f32 v21, v21
v_mfma_f32_16x16x32_bf16 v[28:31], a[168:171], v[88:91], v[28:31]
v_exp_f32 v22, v22
v_mfma_f32_16x16x32_bf16 v[28:31], a[164:167], v[84:87], v[28:31]
v_exp_f32 v23, v23
v_mfma_f32_16x16x32_bf16 v[28:31], a[160:163], v[80:83], v[28:31]
v_exp_f32 v24, v24
v_smfmac_f32_16x16x64_bf16 a[232:235], a[240:243], v[160:167], v127
v_exp_f32 v25, v25
v_smfmac_f32_16x16x64_bf16 a[232:235], a[240:243], v[168:175], v127
v_cvt_pk_bf16_f32 v214, v36, v37
v_cvt_pk_bf16_f32 v215, v38, v39
v_smfmac_f32_16x16x64_bf16 a[236:239], a[240:243], v[176:183], v127
v_exp_f32 v26, v26
v_smfmac_f32_16x16x64_bf16 a[236:239], a[240:243], v[184:191], v127
v_cvt_pk_bf16_f32 v230, v40, v41
s_waitcnt lgkmcnt(0)
v_mfma_f32_16x16x32_bf16 v[32:35], a[192:195], a[128:131], v[48:51]
v_exp_f32 v27, v27
v_mfma_f32_16x16x32_bf16 v[32:35], a[196:199], a[132:135], v[32:35]
v_exp_f32 v28, v28
v_mfma_f32_16x16x32_bf16 v[32:35], a[200:203], a[136:139], v[32:35]
v_exp_f32 v29, v29
v_mfma_f32_16x16x32_bf16 v[32:35], a[204:207], a[140:143], v[32:35]
ds_read_b128 a[160:163], v4 offset:51200
v_cvt_pk_bf16_f32 v231, v42, v43
v_mfma_f32_16x16x32_bf16 v[36:39], a[204:207], a[156:159], v[52:55]
v_exp_f32 v30, v30
v_mfma_f32_16x16x32_bf16 v[36:39], a[200:203], a[152:155], v[36:39]
v_exp_f32 v31, v31
v_mfma_f32_16x16x32_bf16 v[36:39], a[196:199], a[148:151], v[36:39]
ds_read_b128 a[164:167], v5 offset:51200
ds_read_b128 a[168:171], v6 offset:51200
v_mfma_f32_16x16x32_bf16 v[36:39], a[192:195], a[144:147], v[36:39]
v_exp_f32 v32, v32
v_mfma_f32_16x16x32_bf16 v[40:43], a[192:195], v[64:67], v[56:59]
v_exp_f32 v33, v33
v_mfma_f32_16x16x32_bf16 v[40:43], a[196:199], v[68:71], v[40:43]
ds_read_b128 a[172:175], v7 offset:51200
v_cvt_pk_bf16_f32 v246, v44, v45
v_mfma_f32_16x16x32_bf16 v[40:43], a[200:203], v[72:75], v[40:43]
v_cvt_pk_bf16_f32 v247, v46, v47
v_cvt_pk_bf16_f32 v200, v16, v17
v_mfma_f32_16x16x32_bf16 v[40:43], a[204:207], v[76:79], v[40:43]
v_exp_f32 v34, v34
v_mfma_f32_16x16x32_bf16 v[44:47], a[204:207], v[92:95], v[60:63]
v_exp_f32 v35, v35
v_mfma_f32_16x16x32_bf16 v[44:47], a[200:203], v[88:91], v[44:47]
v_exp_f32 v36, v36
v_mfma_f32_16x16x32_bf16 v[44:47], a[196:199], v[84:87], v[44:47]
v_exp_f32 v37, v37
v_mfma_f32_16x16x32_bf16 v[44:47], a[192:195], v[80:83], v[44:47]
v_exp_f32 v38, v38
v_smfmac_f32_16x16x64_bf16 a[224:227], a[240:243], v[192:199], v127
v_cvt_pk_bf16_f32 v201, v18, v19
v_cvt_pk_bf16_f32 v216, v20, v21
v_smfmac_f32_16x16x64_bf16 a[228:231], a[240:243], v[208:215], v127
v_exp_f32 v39, v39
v_smfmac_f32_16x16x64_bf16 a[232:235], a[240:243], v[224:231], v127
v_exp_f32 v40, v40
v_smfmac_f32_16x16x64_bf16 a[236:239], a[240:243], v[240:247], v127
v_cvt_pk_bf16_f32 v217, v22, v23
s_waitcnt lgkmcnt(0)
v_mfma_f32_16x16x32_bf16 v[16:19], a[160:163], a[128:131], v[48:51]
v_exp_f32 v41, v41
v_mfma_f32_16x16x32_bf16 v[16:19], a[164:167], a[132:135], v[16:19]
v_exp_f32 v42, v42
v_mfma_f32_16x16x32_bf16 v[16:19], a[168:171], a[136:139], v[16:19]
ds_read_b128 a[192:195], v4 offset:52224
ds_read_b128 a[196:199], v5 offset:52224
v_mfma_f32_16x16x32_bf16 v[16:19], a[172:175], a[140:143], v[16:19]
v_exp_f32 v43, v43
v_mfma_f32_16x16x32_bf16 v[20:23], a[172:175], a[156:159], v[52:55]
v_exp_f32 v44, v44
v_mfma_f32_16x16x32_bf16 v[20:23], a[168:171], a[152:155], v[20:23]
ds_read_b128 a[200:203], v6 offset:52224
ds_read_b128 a[204:207], v7 offset:52224
v_mfma_f32_16x16x32_bf16 v[20:23], a[164:167], a[148:151], v[20:23]
v_cvt_pk_bf16_f32 v232, v24, v25
v_cvt_pk_bf16_f32 v233, v26, v27
v_mfma_f32_16x16x32_bf16 v[20:23], a[160:163], a[144:147], v[20:23]
v_exp_f32 v45, v45
v_mfma_f32_16x16x32_bf16 v[24:27], a[160:163], v[64:67], v[56:59]
v_exp_f32 v46, v46
v_mfma_f32_16x16x32_bf16 v[24:27], a[164:167], v[68:71], v[24:27]
v_exp_f32 v47, v47
v_mfma_f32_16x16x32_bf16 v[24:27], a[168:171], v[72:75], v[24:27]
v_cvt_pk_bf16_f32 v248, v28, v29
v_cvt_pk_bf16_f32 v249, v30, v31
v_cvt_pk_bf16_f32 v202, v32, v33
v_mfma_f32_16x16x32_bf16 v[24:27], a[172:175], v[76:79], v[24:27]
v_exp_f32 v16, v16
v_mfma_f32_16x16x32_bf16 v[28:31], a[172:175], v[92:95], v[60:63]
v_exp_f32 v17, v17
v_mfma_f32_16x16x32_bf16 v[28:31], a[168:171], v[88:91], v[28:31]
v_cvt_pk_bf16_f32 v203, v34, v35
v_exp_f32 v18, v18
v_mfma_f32_16x16x32_bf16 v[28:31], a[164:167], v[84:87], v[28:31]
v_exp_f32 v19, v19
v_mfma_f32_16x16x32_bf16 v[28:31], a[160:163], v[80:83], v[28:31]
v_cvt_pk_bf16_f32 v218, v36, v37
s_waitcnt vmcnt(0) lgkmcnt(0)
s_barrier
v_mfma_f32_16x16x32_bf16 v[32:35], a[192:195], a[128:131], v[48:51]
v_exp_f32 v20, v20
v_mfma_f32_16x16x32_bf16 v[32:35], a[196:199], a[132:135], v[32:35]
v_cvt_pk_bf16_f32 v219, v38, v39
v_cvt_pk_bf16_f32 v234, v40, v41
v_mfma_f32_16x16x32_bf16 v[32:35], a[200:203], a[136:139], v[32:35]
v_cvt_pk_bf16_f32 v235, v42, v43
v_exp_f32 v21, v21
v_mfma_f32_16x16x32_bf16 v[32:35], a[204:207], a[140:143], v[32:35]
v_exp_f32 v22, v22
v_mfma_f32_16x16x32_bf16 v[36:39], a[204:207], a[156:159], v[52:55]
v_exp_f32 v23, v23
v_mfma_f32_16x16x32_bf16 v[36:39], a[200:203], a[152:155], v[36:39]
ds_read_b64_tr_b16 a[176:177], v8 offset:32768
ds_read_b64_tr_b16 a[178:179], v8 offset:33792
ds_read_b64_tr_b16 a[180:181], v8 offset:34816
v_mfma_f32_16x16x32_bf16 v[36:39], a[196:199], a[148:151], v[36:39]
ds_read_b64_tr_b16 a[182:183], v8 offset:35840
ds_read_b64_tr_b16 a[184:185], v8 offset:49152
v_mfma_f32_16x16x32_bf16 v[36:39], a[192:195], a[144:147], v[36:39]
ds_read_b64_tr_b16 a[186:187], v8 offset:50176
ds_read_b64_tr_b16 a[188:189], v8 offset:51200
ds_read_b64_tr_b16 a[190:191], v8 offset:52224
v_mfma_f32_16x16x32_bf16 v[40:43], a[192:195], v[64:67], v[56:59]
v_exp_f32 v24, v24
v_mfma_f32_16x16x32_bf16 v[40:43], a[196:199], v[68:71], v[40:43]
v_cvt_pk_bf16_f32 v250, v44, v45
v_exp_f32 v25, v25
v_mfma_f32_16x16x32_bf16 v[40:43], a[200:203], v[72:75], v[40:43]
v_exp_f32 v26, v26
v_mfma_f32_16x16x32_bf16 v[40:43], a[204:207], v[76:79], v[40:43]
v_cvt_pk_bf16_f32 v251, v46, v47
v_exp_f32 v27, v27
v_mfma_f32_16x16x32_bf16 v[44:47], a[204:207], v[92:95], v[60:63]
v_exp_f32 v28, v28
v_mfma_f32_16x16x32_bf16 v[44:47], a[200:203], v[88:91], v[44:47]
ds_read_b64_tr_b16 a[208:209], v9 offset:32768
v_exp_f32 v29, v29
v_mfma_f32_16x16x32_bf16 v[44:47], a[196:199], v[84:87], v[44:47]
v_exp_f32 v30, v30
v_mfma_f32_16x16x32_bf16 v[44:47], a[192:195], v[80:83], v[44:47]
ds_read_b64_tr_b16 a[210:211], v9 offset:33792
ds_read_b64_tr_b16 a[212:213], v9 offset:34816
s_waitcnt lgkmcnt(3)
v_mfma_f32_16x16x32_bf16 a[0:3], v[192:195], a[176:179], a[0:3]
ds_read_b64_tr_b16 a[160:161], v10 offset:0
ds_read_b64_tr_b16 a[162:163], v10 offset:1024
v_mfma_f32_16x16x32_bf16 a[0:3], v[196:199], a[180:183], a[0:3]
ds_read_b64_tr_b16 a[214:215], v9 offset:35840
v_exp_f32 v31, v31
v_mfma_f32_16x16x32_bf16 a[0:3], v[200:203], a[184:187], a[0:3]
v_exp_f32 v32, v32
v_mfma_f32_16x16x32_bf16 a[4:7], v[216:219], a[184:187], a[4:7]
ds_read_b64_tr_b16 a[216:217], v9 offset:49152
ds_read_b64_tr_b16 a[218:219], v9 offset:50176
ds_read_b64_tr_b16 a[220:221], v9 offset:51200
v_mfma_f32_16x16x32_bf16 a[4:7], v[212:215], a[180:183], a[4:7]
ds_read_b64_tr_b16 a[222:223], v9 offset:52224
ds_read_b64_tr_b16 a[164:165], v10 offset:2048
v_mfma_f32_16x16x32_bf16 a[4:7], v[208:211], a[176:179], a[4:7]
v_exp_f32 v33, v33
v_mfma_f32_16x16x32_bf16 a[8:11], v[224:227], a[176:179], a[8:11]
ds_read_b64_tr_b16 a[166:167], v10 offset:3072
v_exp_f32 v34, v34
v_mfma_f32_16x16x32_bf16 a[8:11], v[228:231], a[180:183], a[8:11]
ds_read_b64_tr_b16 a[168:169], v10 offset:16384
v_exp_f32 v35, v35
v_mfma_f32_16x16x32_bf16 a[8:11], v[232:235], a[184:187], a[8:11]
ds_read_b64_tr_b16 a[170:171], v10 offset:17408
v_exp_f32 v36, v36
v_mfma_f32_16x16x32_bf16 a[12:15], v[248:251], a[184:187], a[12:15]
v_exp_f32 v37, v37
v_mfma_f32_16x16x32_bf16 a[12:15], v[244:247], a[180:183], a[12:15]
ds_read_b64_tr_b16 a[172:173], v10 offset:18432
v_exp_f32 v38, v38
v_mfma_f32_16x16x32_bf16 a[12:15], v[240:243], a[176:179], a[12:15]
ds_read_b64_tr_b16 a[174:175], v10 offset:19456
ds_read_b64_tr_b16 a[192:193], v10 offset:32768
s_waitcnt lgkmcnt(7)
v_mfma_f32_16x16x32_bf16 a[16:19], v[192:195], a[208:211], a[16:19]
ds_read_b64_tr_b16 a[194:195], v10 offset:33792
v_exp_f32 v39, v39
v_mfma_f32_16x16x32_bf16 a[16:19], v[196:199], a[212:215], a[16:19]
ds_read_b64_tr_b16 a[196:197], v10 offset:34816
v_exp_f32 v40, v40
v_mfma_f32_16x16x32_bf16 a[16:19], v[200:203], a[216:219], a[16:19]
ds_read_b64_tr_b16 a[198:199], v10 offset:35840
v_exp_f32 v41, v41
v_mfma_f32_16x16x32_bf16 a[20:23], v[216:219], a[216:219], a[20:23]
ds_read_b64_tr_b16 a[200:201], v10 offset:49152
v_cvt_pk_bf16_f32 v204, v16, v17
v_cvt_pk_bf16_f32 v205, v18, v19
v_mfma_f32_16x16x32_bf16 a[20:23], v[212:215], a[212:215], a[20:23]
v_exp_f32 v42, v42
v_mfma_f32_16x16x32_bf16 a[20:23], v[208:211], a[208:211], a[20:23]
v_cvt_pk_bf16_f32 v206, v32, v33
v_exp_f32 v43, v43
v_mfma_f32_16x16x32_bf16 a[24:27], v[224:227], a[208:211], a[24:27]
ds_read_b64_tr_b16 a[202:203], v10 offset:50176
v_cvt_pk_bf16_f32 v220, v20, v21
v_cvt_pk_bf16_f32 v207, v34, v35
v_mfma_f32_16x16x32_bf16 a[24:27], v[228:231], a[212:215], a[24:27]
v_cvt_pk_bf16_f32 v221, v22, v23
v_exp_f32 v44, v44
v_mfma_f32_16x16x32_bf16 a[24:27], v[232:235], a[216:219], a[24:27]
v_cvt_pk_bf16_f32 v222, v36, v37
v_exp_f32 v45, v45
v_mfma_f32_16x16x32_bf16 a[28:31], v[248:251], a[216:219], a[28:31]
v_cvt_pk_bf16_f32 v236, v24, v25
v_cvt_pk_bf16_f32 v237, v26, v27
v_cvt_pk_bf16_f32 v223, v38, v39
v_mfma_f32_16x16x32_bf16 a[28:31], v[244:247], a[212:215], a[28:31]
v_exp_f32 v46, v46
v_mfma_f32_16x16x32_bf16 a[28:31], v[240:243], a[208:211], a[28:31]
ds_read_b64_tr_b16 a[204:205], v10 offset:51200
v_cvt_pk_bf16_f32 v238, v40, v41
v_cvt_pk_bf16_f32 v239, v42, v43
v_smfmac_f32_16x16x64_bf16 a[224:227], a[240:243], v[200:207], v127
v_cvt_pk_bf16_f32 v252, v28, v29
v_exp_f32 v47, v47
v_smfmac_f32_16x16x64_bf16 a[228:231], a[240:243], v[216:223], v127
v_cvt_pk_bf16_f32 v253, v30, v31
v_cvt_pk_bf16_f32 v254, v44, v45
v_cvt_pk_bf16_f32 v255, v46, v47
v_smfmac_f32_16x16x64_bf16 a[232:235], a[240:243], v[232:239], v127
ds_read_b64_tr_b16 a[206:207], v10 offset:52224
v_smfmac_f32_16x16x64_bf16 a[236:239], a[240:243], v[248:255], v127
v_mfma_f32_16x16x32_bf16 a[0:3], v[204:207], a[188:191], a[0:3]
v_mfma_f32_16x16x32_bf16 a[4:7], v[220:223], a[188:191], a[4:7]
v_mfma_f32_16x16x32_bf16 a[8:11], v[236:239], a[188:191], a[8:11]
v_mfma_f32_16x16x32_bf16 a[12:15], v[252:255], a[188:191], a[12:15]
v_accvgpr_read_b32 v118, a224
v_accvgpr_read_b32 v106, a225
v_add_f32 v118, v118, v106
v_rcp_f32 v106, v118
v_mfma_f32_16x16x32_bf16 a[16:19], v[204:207], a[220:223], a[16:19]
ds_bpermute_b32 v106, v114, v106
v_mfma_f32_16x16x32_bf16 a[20:23], v[220:223], a[220:223], a[20:23]
v_accvgpr_read_b32 v119, a228
v_accvgpr_read_b32 v107, a229
v_add_f32 v119, v119, v107
v_accvgpr_read_b32 v120, a232
v_mfma_f32_16x16x32_bf16 a[24:27], v[236:239], a[220:223], a[24:27]
v_rcp_f32 v107, v119
v_accvgpr_read_b32 v108, a233
v_add_f32 v120, v120, v108
v_accvgpr_read_b32 v121, a236
v_mfma_f32_16x16x32_bf16 a[28:31], v[252:255], a[220:223], a[28:31]
v_rcp_f32 v108, v120
v_accvgpr_read_b32 v109, a237
s_waitcnt lgkmcnt(1)
v_mfma_f32_16x16x32_bf16 a[32:35], v[128:131], a[160:163], a[32:35]
ds_read_b64_tr_b16 a[176:177], v11 offset:0
ds_read_b64_tr_b16 a[178:179], v11 offset:1024
ds_read_b64_tr_b16 a[180:181], v11 offset:2048
v_add_f32 v121, v121, v109
v_mfma_f32_16x16x32_bf16 a[32:35], v[132:135], a[164:167], a[32:35]
v_accvgpr_read_b32 v16, a0
v_accvgpr_read_b32 v17, a1
v_accvgpr_read_b32 v18, a2
v_accvgpr_read_b32 v19, a3
v_mfma_f32_16x16x32_bf16 a[32:35], v[136:139], a[168:171], a[32:35]
ds_read_b64_tr_b16 a[182:183], v11 offset:3072
ds_bpermute_b32 v107, v114, v107
v_rcp_f32 v109, v121
s_waitcnt lgkmcnt(5)
v_mul_f32_dpp v16, v106, v16 row_newbcast:0 row_mask:0xf bank_mask:0xf
v_mfma_f32_16x16x32_bf16 a[32:35], v[140:143], a[172:175], a[32:35]
ds_bpermute_b32 v108, v114, v108
ds_bpermute_b32 v109, v114, v109
v_mul_f32_dpp v17, v106, v17 row_newbcast:1 row_mask:0xf bank_mask:0xf
v_mfma_f32_16x16x32_bf16 a[32:35], v[192:195], a[192:195], a[32:35]
ds_read_b64_tr_b16 a[184:185], v11 offset:16384
v_mul_f32_dpp v18, v106, v18 row_newbcast:2 row_mask:0xf bank_mask:0xf
v_mul_f32_dpp v19, v106, v19 row_newbcast:3 row_mask:0xf bank_mask:0xf
v_cvt_pk_bf16_f32 v24, v16, v17
v_cvt_pk_bf16_f32 v25, v18, v19
v_accvgpr_read_b32 v20, a16
v_accvgpr_read_b32 v21, a17
v_mfma_f32_16x16x32_bf16 a[32:35], v[196:199], a[196:199], a[32:35]
ds_read_b64_tr_b16 a[186:187], v11 offset:17408
ds_write_b64 v113, v[24:25] offset:0
v_accvgpr_read_b32 v22, a18
v_accvgpr_read_b32 v23, a19
v_mfma_f32_16x16x32_bf16 a[32:35], v[200:203], a[200:203], a[32:35]
ds_read_b64_tr_b16 a[188:189], v11 offset:18432
v_mul_f32_dpp v20, v106, v20 row_newbcast:0 row_mask:0xf bank_mask:0xf
v_mul_f32_dpp v21, v106, v21 row_newbcast:1 row_mask:0xf bank_mask:0xf
v_mul_f32_dpp v22, v106, v22 row_newbcast:2 row_mask:0xf bank_mask:0xf
v_mul_f32_dpp v23, v106, v23 row_newbcast:3 row_mask:0xf bank_mask:0xf
v_cvt_pk_bf16_f32 v26, v20, v21
v_cvt_pk_bf16_f32 v27, v22, v23
v_mfma_f32_16x16x32_bf16 a[32:35], v[204:207], a[204:207], a[32:35]
ds_read_b64_tr_b16 a[190:191], v11 offset:19456
ds_read_b64_tr_b16 a[208:209], v11 offset:32768
v_accvgpr_read_b32 v16, a4
v_accvgpr_read_b32 v17, a5
v_accvgpr_read_b32 v18, a6
v_accvgpr_read_b32 v19, a7
s_waitcnt lgkmcnt(8)
v_mul_f32_dpp v16, v107, v16 row_newbcast:0 row_mask:0xf bank_mask:0xf
v_mfma_f32_16x16x32_bf16 a[36:39], v[220:223], a[204:207], a[36:39]
ds_read_b64_tr_b16 a[210:211], v11 offset:33792
ds_write_b64 v113, v[26:27] offset:128
ds_read_b64_tr_b16 v[32:33], v115 offset:0
ds_read_b64_tr_b16 v[34:35], v116 offset:0
v_mul_f32_dpp v17, v107, v17 row_newbcast:1 row_mask:0xf bank_mask:0xf
v_mfma_f32_16x16x32_bf16 a[36:39], v[216:219], a[200:203], a[36:39]
ds_read_b64_tr_b16 a[212:213], v11 offset:34816
v_mul_f32_dpp v18, v107, v18 row_newbcast:2 row_mask:0xf bank_mask:0xf
v_mul_f32_dpp v19, v107, v19 row_newbcast:3 row_mask:0xf bank_mask:0xf
v_cvt_pk_bf16_f32 v28, v16, v17
v_cvt_pk_bf16_f32 v29, v18, v19
v_accvgpr_read_b32 v20, a20
v_mfma_f32_16x16x32_bf16 a[36:39], v[212:215], a[196:199], a[36:39]
ds_read_b64_tr_b16 a[214:215], v11 offset:35840
ds_write_b64 v113, v[28:29] offset:1024
v_accvgpr_read_b32 v21, a21
v_accvgpr_read_b32 v22, a22
v_accvgpr_read_b32 v23, a23
v_mfma_f32_16x16x32_bf16 a[36:39], v[208:211], a[192:195], a[36:39]
v_mul_f32_dpp v20, v107, v20 row_newbcast:0 row_mask:0xf bank_mask:0xf
v_mul_f32_dpp v21, v107, v21 row_newbcast:1 row_mask:0xf bank_mask:0xf
v_mul_f32_dpp v22, v107, v22 row_newbcast:2 row_mask:0xf bank_mask:0xf
v_mul_f32_dpp v23, v107, v23 row_newbcast:3 row_mask:0xf bank_mask:0xf
v_cvt_pk_bf16_f32 v30, v20, v21
v_cvt_pk_bf16_f32 v31, v22, v23
v_accvgpr_read_b32 v16, a8
v_mfma_f32_16x16x32_bf16 a[36:39], v[156:159], a[172:175], a[36:39]
v_accvgpr_read_b32 v17, a9
v_accvgpr_read_b32 v18, a10
v_accvgpr_read_b32 v19, a11
s_waitcnt lgkmcnt(14)
v_mul_f32_dpp v16, v108, v16 row_newbcast:0 row_mask:0xf bank_mask:0xf
v_mul_f32_dpp v17, v108, v17 row_newbcast:1 row_mask:0xf bank_mask:0xf
v_mul_f32_dpp v18, v108, v18 row_newbcast:2 row_mask:0xf bank_mask:0xf
v_mul_f32_dpp v19, v108, v19 row_newbcast:3 row_mask:0xf bank_mask:0xf
v_mfma_f32_16x16x32_bf16 a[36:39], v[152:155], a[168:171], a[36:39]
ds_read_b64_tr_b16 a[216:217], v11 offset:49152
ds_write_b64 v113, v[30:31] offset:1152
v_cvt_pk_bf16_f32 v24, v16, v17
v_cvt_pk_bf16_f32 v25, v18, v19
v_accvgpr_read_b32 v20, a24
v_mfma_f32_16x16x32_bf16 a[36:39], v[148:151], a[164:167], a[36:39]
ds_write_b64 v113, v[24:25] offset:2048
v_accvgpr_read_b32 v21, a25
v_accvgpr_read_b32 v22, a26
v_accvgpr_read_b32 v23, a27
v_mfma_f32_16x16x32_bf16 a[36:39], v[144:147], a[160:163], a[36:39]
v_mul_f32_dpp v20, v108, v20 row_newbcast:0 row_mask:0xf bank_mask:0xf
v_mul_f32_dpp v21, v108, v21 row_newbcast:1 row_mask:0xf bank_mask:0xf
v_mul_f32_dpp v22, v108, v22 row_newbcast:2 row_mask:0xf bank_mask:0xf
v_mul_f32_dpp v23, v108, v23 row_newbcast:3 row_mask:0xf bank_mask:0xf
v_cvt_pk_bf16_f32 v26, v20, v21
v_cvt_pk_bf16_f32 v27, v22, v23
v_accvgpr_read_b32 v16, a12
v_mfma_f32_16x16x32_bf16 a[40:43], v[160:163], a[160:163], a[40:43]
v_accvgpr_read_b32 v17, a13
v_accvgpr_read_b32 v18, a14
v_accvgpr_read_b32 v19, a15
s_waitcnt lgkmcnt(15)
v_mul_f32_dpp v16, v109, v16 row_newbcast:0 row_mask:0xf bank_mask:0xf
v_mul_f32_dpp v17, v109, v17 row_newbcast:1 row_mask:0xf bank_mask:0xf
v_mul_f32_dpp v18, v109, v18 row_newbcast:2 row_mask:0xf bank_mask:0xf
v_mul_f32_dpp v19, v109, v19 row_newbcast:3 row_mask:0xf bank_mask:0xf
v_mfma_f32_16x16x32_bf16 a[40:43], v[164:167], a[164:167], a[40:43]
v_cvt_pk_bf16_f32 v28, v16, v17
v_cvt_pk_bf16_f32 v29, v18, v19
v_accvgpr_read_b32 v20, a28
v_accvgpr_read_b32 v21, a29
v_accvgpr_read_b32 v22, a30
v_accvgpr_read_b32 v23, a31
v_mfma_f32_16x16x32_bf16 a[40:43], v[168:171], a[168:171], a[40:43]
v_mul_f32_dpp v20, v109, v20 row_newbcast:0 row_mask:0xf bank_mask:0xf
v_mul_f32_dpp v21, v109, v21 row_newbcast:1 row_mask:0xf bank_mask:0xf
v_mul_f32_dpp v22, v109, v22 row_newbcast:2 row_mask:0xf bank_mask:0xf
v_mul_f32_dpp v23, v109, v23 row_newbcast:3 row_mask:0xf bank_mask:0xf
v_cvt_pk_bf16_f32 v30, v20, v21
v_cvt_pk_bf16_f32 v31, v22, v23
v_accvgpr_read_b32 v16, a32
v_mfma_f32_16x16x32_bf16 a[40:43], v[172:175], a[172:175], a[40:43]
s_waitcnt lgkmcnt(6)
buffer_store_dwordx4 v[32:35], v101, s[20:23], s48 offen offset:0 sc1
v_accvgpr_read_b32 v17, a33
v_accvgpr_read_b32 v18, a34
v_mfma_f32_16x16x32_bf16 a[40:43], v[224:227], a[192:195], a[40:43]
ds_read_b64_tr_b16 a[218:219], v11 offset:50176
ds_read_b64_tr_b16 a[220:221], v11 offset:51200
v_max3_f32 v126, v118, v119, v120
v_accvgpr_read_b32 v19, a35
v_mfma_f32_16x16x32_bf16 a[40:43], v[228:231], a[196:199], a[40:43]
v_max_f32 v126, v126, v121
v_cmp_nge_f32 vcc, 0x53800000, v126
v_mul_f32_dpp v16, v106, v16 row_newbcast:0 row_mask:0xf bank_mask:0xf
v_mul_f32_dpp v17, v106, v17 row_newbcast:1 row_mask:0xf bank_mask:0xf
v_mfma_f32_16x16x32_bf16 a[40:43], v[232:235], a[200:203], a[40:43]
ds_read_b64_tr_b16 v[36:37], v115 offset:1024
ds_read_b64_tr_b16 v[38:39], v116 offset:1024
v_mul_f32_dpp v18, v106, v18 row_newbcast:2 row_mask:0xf bank_mask:0xf
v_mul_f32_dpp v19, v106, v19 row_newbcast:3 row_mask:0xf bank_mask:0xf
v_mfma_f32_16x16x32_bf16 a[40:43], v[236:239], a[204:207], a[40:43]
ds_read_b64_tr_b16 a[222:223], v11 offset:52224
s_or_b32 s29, vcc_lo, vcc_hi
v_cvt_pk_bf16_f32 v24, v16, v17
v_cvt_pk_bf16_f32 v25, v18, v19
v_mfma_f32_16x16x32_bf16 a[44:47], v[252:255], a[204:207], a[44:47]
ds_write_b64 v113, v[24:25] offset:0
v_mfma_f32_16x16x32_bf16 a[44:47], v[248:251], a[200:203], a[44:47]
ds_write_b64 v113, v[26:27] offset:2176
v_accvgpr_read_b32 v20, a36
v_mfma_f32_16x16x32_bf16 a[44:47], v[244:247], a[196:199], a[44:47]
v_mov_b32 v126, s29
v_accvgpr_read_b32 v21, a37
v_accvgpr_read_b32 v22, a38
v_mfma_f32_16x16x32_bf16 a[44:47], v[240:243], a[192:195], a[44:47]
ds_write_b32 v110, v126
ds_read_b64_tr_b16 v[40:41], v115 offset:2048
v_accvgpr_read_b32 v23, a39
v_mfma_f32_16x16x32_bf16 a[44:47], v[188:191], a[172:175], a[44:47]
ds_read_b64_tr_b16 v[42:43], v116 offset:2048
v_mul_f32_dpp v20, v107, v20 row_newbcast:0 row_mask:0xf bank_mask:0xf
v_mul_f32_dpp v21, v107, v21 row_newbcast:1 row_mask:0xf bank_mask:0xf
v_mul_f32_dpp v22, v107, v22 row_newbcast:2 row_mask:0xf bank_mask:0xf
v_mfma_f32_16x16x32_bf16 a[44:47], v[184:187], a[168:171], a[44:47]
v_mul_f32_dpp v23, v107, v23 row_newbcast:3 row_mask:0xf bank_mask:0xf
v_cvt_pk_bf16_f32 v26, v20, v21
v_cvt_pk_bf16_f32 v27, v22, v23
v_mfma_f32_16x16x32_bf16 a[44:47], v[180:183], a[164:167], a[44:47]
ds_write_b64 v113, v[28:29] offset:3072
v_mfma_f32_16x16x32_bf16 a[44:47], v[176:179], a[160:163], a[44:47]
ds_write_b64 v113, v[26:27] offset:1024
s_waitcnt lgkmcnt(7)
v_mfma_f32_16x16x32_bf16 a[48:51], v[128:131], a[176:179], a[48:51]
ds_read_b64_tr_b16 a[160:161], v12 offset:0
ds_read_b64_tr_b16 a[162:163], v12 offset:1024
v_accvgpr_read_b32 v16, a40
v_mfma_f32_16x16x32_bf16 a[48:51], v[132:135], a[180:183], a[48:51]
buffer_store_dwordx4 v[36:39], v101, s[20:23], s49 offen offset:0 sc1
v_mfma_f32_16x16x32_bf16 a[48:51], v[136:139], a[184:187], a[48:51]
ds_read_b64_tr_b16 a[164:165], v12 offset:2048
v_accvgpr_read_b32 v17, a41
v_accvgpr_read_b32 v18, a42
v_mfma_f32_16x16x32_bf16 a[48:51], v[140:143], a[188:191], a[48:51]
ds_write_b64 v113, v[30:31] offset:3200
v_mfma_f32_16x16x32_bf16 a[48:51], v[192:195], a[208:211], a[48:51]
ds_read_b64_tr_b16 a[166:167], v12 offset:3072
ds_read_b64_tr_b16 v[44:45], v115 offset:3072
v_accvgpr_read_b32 v19, a43
v_mfma_f32_16x16x32_bf16 a[48:51], v[196:199], a[212:215], a[48:51]
ds_read_b64_tr_b16 v[46:47], v116 offset:3072
v_mul_f32_dpp v16, v108, v16 row_newbcast:0 row_mask:0xf bank_mask:0xf
v_mul_f32_dpp v17, v108, v17 row_newbcast:1 row_mask:0xf bank_mask:0xf
v_mfma_f32_16x16x32_bf16 a[48:51], v[200:203], a[216:219], a[48:51]
ds_read_b64_tr_b16 a[168:169], v12 offset:16384
v_mul_f32_dpp v18, v108, v18 row_newbcast:2 row_mask:0xf bank_mask:0xf
v_mul_f32_dpp v19, v108, v19 row_newbcast:3 row_mask:0xf bank_mask:0xf
v_mfma_f32_16x16x32_bf16 a[48:51], v[204:207], a[220:223], a[48:51]
ds_read_b64_tr_b16 a[170:171], v12 offset:17408
v_cvt_pk_bf16_f32 v28, v16, v17
v_cvt_pk_bf16_f32 v29, v18, v19
v_mfma_f32_16x16x32_bf16 a[52:55], v[220:223], a[220:223], a[52:55]
ds_write_b64 v113, v[28:29] offset:2048
v_mfma_f32_16x16x32_bf16 a[52:55], v[216:219], a[216:219], a[52:55]
ds_read_b64_tr_b16 a[172:173], v12 offset:18432
v_mov_b32 v126, 131072
v_accvgpr_read_b32 v20, a44
v_mfma_f32_16x16x32_bf16 a[52:55], v[212:215], a[212:215], a[52:55]
ds_read_b64_tr_b16 a[174:175], v12 offset:19456
v_accvgpr_read_b32 v21, a45
v_accvgpr_read_b32 v22, a46
v_mfma_f32_16x16x32_bf16 a[52:55], v[208:211], a[208:211], a[52:55]
ds_read_b64_tr_b16 a[192:193], v12 offset:32768
v_accvgpr_read_b32 v23, a47
v_mul_f32_dpp v20, v109, v20 row_newbcast:0 row_mask:0xf bank_mask:0xf
v_mfma_f32_16x16x32_bf16 a[52:55], v[156:159], a[188:191], a[52:55]
ds_read_b64_tr_b16 a[194:195], v12 offset:33792
v_mul_f32_dpp v21, v109, v21 row_newbcast:1 row_mask:0xf bank_mask:0xf
v_mul_f32_dpp v22, v109, v22 row_newbcast:2 row_mask:0xf bank_mask:0xf
v_mfma_f32_16x16x32_bf16 a[52:55], v[152:155], a[184:187], a[52:55]
s_waitcnt lgkmcnt(15)
buffer_store_dwordx4 v[40:43], v101, s[20:23], s50 offen offset:0 sc1
v_mfma_f32_16x16x32_bf16 a[52:55], v[148:151], a[180:183], a[52:55]
ds_read_b64_tr_b16 a[196:197], v12 offset:34816
v_mul_f32_dpp v23, v109, v23 row_newbcast:3 row_mask:0xf bank_mask:0xf
v_mfma_f32_16x16x32_bf16 a[52:55], v[144:147], a[176:179], a[52:55]
v_cvt_pk_bf16_f32 v30, v20, v21
v_cvt_pk_bf16_f32 v31, v22, v23
v_mfma_f32_16x16x32_bf16 a[56:59], v[160:163], a[176:179], a[56:59]
ds_read_b64_tr_b16 a[198:199], v12 offset:35840
ds_read_b64_tr_b16 a[200:201], v12 offset:49152
v_mfma_f32_16x16x32_bf16 a[56:59], v[164:167], a[180:183], a[56:59]
ds_write_b64 v113, v[30:31] offset:3072
v_mfma_f32_16x16x32_bf16 a[56:59], v[168:171], a[184:187], a[56:59]
v_accvgpr_read_b32 v16, a48
v_accvgpr_read_b32 v17, a49
v_accvgpr_read_b32 v18, a50
v_mfma_f32_16x16x32_bf16 a[56:59], v[172:175], a[188:191], a[56:59]
ds_read_b64_tr_b16 a[202:203], v12 offset:50176
v_accvgpr_read_b32 v19, a51
v_mfma_f32_16x16x32_bf16 a[56:59], v[224:227], a[208:211], a[56:59]
ds_read_b64_tr_b16 a[204:205], v12 offset:51200
v_mul_f32_dpp v16, v106, v16 row_newbcast:0 row_mask:0xf bank_mask:0xf
v_mul_f32_dpp v17, v106, v17 row_newbcast:1 row_mask:0xf bank_mask:0xf
v_mfma_f32_16x16x32_bf16 a[56:59], v[228:231], a[212:215], a[56:59]
ds_read_b64_tr_b16 a[206:207], v12 offset:52224
v_mul_f32_dpp v18, v106, v18 row_newbcast:2 row_mask:0xf bank_mask:0xf
v_mul_f32_dpp v19, v106, v19 row_newbcast:3 row_mask:0xf bank_mask:0xf
v_mfma_f32_16x16x32_bf16 a[56:59], v[232:235], a[216:219], a[56:59]
v_cvt_pk_bf16_f32 v24, v16, v17
v_cvt_pk_bf16_f32 v25, v18, v19
v_accvgpr_read_b32 v20, a52
v_mfma_f32_16x16x32_bf16 a[56:59], v[236:239], a[220:223], a[56:59]
ds_write_b64 v113, v[24:25] offset:128
v_mfma_f32_16x16x32_bf16 a[60:63], v[252:255], a[220:223], a[60:63]
ds_read_b64_tr_b16 v[32:33], v115 offset:0
ds_read_b64_tr_b16 v[34:35], v116 offset:0
v_mfma_f32_16x16x32_bf16 a[60:63], v[248:251], a[216:219], a[60:63]
v_accvgpr_read_b32 v21, a53
v_accvgpr_read_b32 v22, a54
v_accvgpr_read_b32 v23, a55
v_mfma_f32_16x16x32_bf16 a[60:63], v[244:247], a[212:215], a[60:63]
v_mul_f32_dpp v20, v107, v20 row_newbcast:0 row_mask:0xf bank_mask:0xf
v_mul_f32_dpp v21, v107, v21 row_newbcast:1 row_mask:0xf bank_mask:0xf
v_mul_f32_dpp v22, v107, v22 row_newbcast:2 row_mask:0xf bank_mask:0xf
v_mfma_f32_16x16x32_bf16 a[60:63], v[240:243], a[208:211], a[60:63]
s_waitcnt lgkmcnt(15)
buffer_store_dwordx4 v[44:47], v101, s[20:23], s51 offen offset:0 sc1
v_mfma_f32_16x16x32_bf16 a[60:63], v[188:191], a[188:191], a[60:63]
v_mul_f32_dpp v23, v107, v23 row_newbcast:3 row_mask:0xf bank_mask:0xf
v_cvt_pk_bf16_f32 v26, v20, v21
v_mfma_f32_16x16x32_bf16 a[60:63], v[184:187], a[184:187], a[60:63]
s_waitcnt lgkmcnt(0)
buffer_store_dwordx4 v[32:35], v101, s[20:23], s48 offen offset:64 sc1
v_mfma_f32_16x16x32_bf16 a[60:63], v[180:183], a[180:183], a[60:63]
v_cvt_pk_bf16_f32 v27, v22, v23
v_accvgpr_read_b32 v16, a56
v_mfma_f32_16x16x32_bf16 a[60:63], v[176:179], a[176:179], a[60:63]
v_accvgpr_read_b32 v17, a57
v_mfma_f32_16x16x32_bf16 a[64:67], v[128:131], a[160:163], a[64:67]
ds_read_b64_tr_b16 a[176:177], v13 offset:0
ds_read_b64_tr_b16 a[178:179], v13 offset:1024
v_mfma_f32_16x16x32_bf16 a[64:67], v[132:135], a[164:167], a[64:67]
ds_write_b64 v113, v[26:27] offset:1152
v_mfma_f32_16x16x32_bf16 a[64:67], v[136:139], a[168:171], a[64:67]
ds_read_b64_tr_b16 v[36:37], v115 offset:1024
ds_read_b64_tr_b16 v[38:39], v116 offset:1024
v_mfma_f32_16x16x32_bf16 a[64:67], v[140:143], a[172:175], a[64:67]
ds_read_b64_tr_b16 a[180:181], v13 offset:2048
v_accvgpr_read_b32 v18, a58
v_accvgpr_read_b32 v19, a59
v_mfma_f32_16x16x32_bf16 a[64:67], v[192:195], a[192:195], a[64:67]
ds_read_b64_tr_b16 a[182:183], v13 offset:3072
v_mul_f32_dpp v16, v108, v16 row_newbcast:0 row_mask:0xf bank_mask:0xf
v_mul_f32_dpp v17, v108, v17 row_newbcast:1 row_mask:0xf bank_mask:0xf
v_mfma_f32_16x16x32_bf16 a[64:67], v[196:199], a[196:199], a[64:67]
ds_read_b64_tr_b16 a[184:185], v13 offset:16384
v_mul_f32_dpp v18, v108, v18 row_newbcast:2 row_mask:0xf bank_mask:0xf
v_mul_f32_dpp v19, v108, v19 row_newbcast:3 row_mask:0xf bank_mask:0xf
v_mfma_f32_16x16x32_bf16 a[64:67], v[200:203], a[200:203], a[64:67]
ds_read_b64_tr_b16 a[186:187], v13 offset:17408
v_cvt_pk_bf16_f32 v28, v16, v17
v_cvt_pk_bf16_f32 v29, v18, v19
v_mfma_f32_16x16x32_bf16 a[64:67], v[204:207], a[204:207], a[64:67]
ds_write_b64 v113, v[28:29] offset:2176
v_mfma_f32_16x16x32_bf16 a[68:71], v[220:223], a[204:207], a[68:71]
ds_read_b64_tr_b16 a[188:189], v13 offset:18432
ds_read_b64_tr_b16 v[40:41], v115 offset:2048
ds_read_b64_tr_b16 v[42:43], v116 offset:2048
v_mfma_f32_16x16x32_bf16 a[68:71], v[216:219], a[200:203], a[68:71]
ds_read_b64_tr_b16 a[190:191], v13 offset:19456
v_accvgpr_read_b32 v20, a60
v_accvgpr_read_b32 v21, a61
v_mfma_f32_16x16x32_bf16 a[68:71], v[212:215], a[196:199], a[68:71]
s_waitcnt lgkmcnt(9)
buffer_store_dwordx4 v[36:39], v101, s[20:23], s49 offen offset:64 sc1
v_mfma_f32_16x16x32_bf16 a[68:71], v[208:211], a[192:195], a[68:71]
ds_read_b64_tr_b16 a[208:209], v13 offset:32768
v_accvgpr_read_b32 v22, a62
v_mfma_f32_16x16x32_bf16 a[68:71], v[156:159], a[172:175], a[68:71]
v_accvgpr_read_b32 v23, a63
v_mul_f32_dpp v20, v109, v20 row_newbcast:0 row_mask:0xf bank_mask:0xf
v_mfma_f32_16x16x32_bf16 a[68:71], v[152:155], a[168:171], a[68:71]
ds_read_b64_tr_b16 a[210:211], v13 offset:33792
v_mul_f32_dpp v21, v109, v21 row_newbcast:1 row_mask:0xf bank_mask:0xf
v_mfma_f32_16x16x32_bf16 a[68:71], v[148:151], a[164:167], a[68:71]
ds_read_b64_tr_b16 a[212:213], v13 offset:34816
v_mul_f32_dpp v22, v109, v22 row_newbcast:2 row_mask:0xf bank_mask:0xf
v_mul_f32_dpp v23, v109, v23 row_newbcast:3 row_mask:0xf bank_mask:0xf
v_mfma_f32_16x16x32_bf16 a[68:71], v[144:147], a[160:163], a[68:71]
ds_read_b64_tr_b16 a[214:215], v13 offset:35840
v_cvt_pk_bf16_f32 v30, v20, v21
v_cvt_pk_bf16_f32 v31, v22, v23
v_mfma_f32_16x16x32_bf16 a[72:75], v[160:163], a[160:163], a[72:75]
ds_write_b64 v113, v[30:31] offset:3200
v_mfma_f32_16x16x32_bf16 a[72:75], v[164:167], a[164:167], a[72:75]
ds_read_b64_tr_b16 a[216:217], v13 offset:49152
ds_read_b64_tr_b16 v[44:45], v115 offset:3072
v_mfma_f32_16x16x32_bf16 a[72:75], v[168:171], a[168:171], a[72:75]
ds_read_b64_tr_b16 v[46:47], v116 offset:3072
v_accvgpr_read_b32 v16, a64
v_accvgpr_read_b32 v17, a65
v_mfma_f32_16x16x32_bf16 a[72:75], v[172:175], a[172:175], a[72:75]
ds_read_b64_tr_b16 a[218:219], v13 offset:50176
v_accvgpr_read_b32 v18, a66
v_accvgpr_read_b32 v19, a67
v_mfma_f32_16x16x32_bf16 a[72:75], v[224:227], a[192:195], a[72:75]
ds_read_b64_tr_b16 a[220:221], v13 offset:51200
v_mul_f32_dpp v16, v106, v16 row_newbcast:0 row_mask:0xf bank_mask:0xf
v_mul_f32_dpp v17, v106, v17 row_newbcast:1 row_mask:0xf bank_mask:0xf
v_mfma_f32_16x16x32_bf16 a[72:75], v[228:231], a[196:199], a[72:75]
ds_read_b64_tr_b16 a[222:223], v13 offset:52224
v_mul_f32_dpp v18, v106, v18 row_newbcast:2 row_mask:0xf bank_mask:0xf
v_mul_f32_dpp v19, v106, v19 row_newbcast:3 row_mask:0xf bank_mask:0xf
v_mfma_f32_16x16x32_bf16 a[72:75], v[232:235], a[200:203], a[72:75]
s_waitcnt lgkmcnt(12)
buffer_store_dwordx4 v[40:43], v101, s[20:23], s50 offen offset:64 sc1
v_mfma_f32_16x16x32_bf16 a[72:75], v[236:239], a[204:207], a[72:75]
v_cvt_pk_bf16_f32 v24, v16, v17
v_cvt_pk_bf16_f32 v25, v18, v19
v_mfma_f32_16x16x32_bf16 a[76:79], v[252:255], a[204:207], a[76:79]
ds_write_b64 v113, v[24:25] offset:0
v_mfma_f32_16x16x32_bf16 a[76:79], v[248:251], a[200:203], a[76:79]
v_accvgpr_read_b32 v20, a68
v_accvgpr_read_b32 v21, a69
v_mfma_f32_16x16x32_bf16 a[76:79], v[244:247], a[196:199], a[76:79]
v_accvgpr_read_b32 v22, a70
v_accvgpr_read_b32 v23, a71
v_mfma_f32_16x16x32_bf16 a[76:79], v[240:243], a[192:195], a[76:79]
v_mul_f32_dpp v20, v107, v20 row_newbcast:0 row_mask:0xf bank_mask:0xf
v_mul_f32_dpp v21, v107, v21 row_newbcast:1 row_mask:0xf bank_mask:0xf
v_mfma_f32_16x16x32_bf16 a[76:79], v[188:191], a[172:175], a[76:79]
v_mul_f32_dpp v22, v107, v22 row_newbcast:2 row_mask:0xf bank_mask:0xf
v_mul_f32_dpp v23, v107, v23 row_newbcast:3 row_mask:0xf bank_mask:0xf
v_mfma_f32_16x16x32_bf16 a[76:79], v[184:187], a[168:171], a[76:79]
v_cvt_pk_bf16_f32 v26, v20, v21
v_cvt_pk_bf16_f32 v27, v22, v23
v_mfma_f32_16x16x32_bf16 a[76:79], v[180:183], a[164:167], a[76:79]
ds_write_b64 v113, v[26:27] offset:1024
v_mfma_f32_16x16x32_bf16 a[76:79], v[176:179], a[160:163], a[76:79]
v_accvgpr_read_b32 v16, a72
s_waitcnt lgkmcnt(2)
v_mfma_f32_16x16x32_bf16 a[80:83], v[128:131], a[176:179], a[80:83]
ds_read_b64_tr_b16 a[160:161], v14 offset:0
ds_read_b64_tr_b16 a[162:163], v14 offset:1024
v_mfma_f32_16x16x32_bf16 a[80:83], v[132:135], a[180:183], a[80:83]
v_accvgpr_read_b32 v17, a73
v_accvgpr_read_b32 v18, a74
v_mfma_f32_16x16x32_bf16 a[80:83], v[136:139], a[184:187], a[80:83]
buffer_store_dwordx4 v[44:47], v101, s[20:23], s51 offen offset:64 sc1
v_mfma_f32_16x16x32_bf16 a[80:83], v[140:143], a[188:191], a[80:83]
ds_read_b64_tr_b16 a[164:165], v14 offset:2048
v_accvgpr_read_b32 v19, a75
v_mfma_f32_16x16x32_bf16 a[80:83], v[192:195], a[208:211], a[80:83]
ds_read_b64_tr_b16 a[166:167], v14 offset:3072
v_mul_f32_dpp v16, v108, v16 row_newbcast:0 row_mask:0xf bank_mask:0xf
v_mfma_f32_16x16x32_bf16 a[80:83], v[196:199], a[212:215], a[80:83]
v_mul_f32_dpp v17, v108, v17 row_newbcast:1 row_mask:0xf bank_mask:0xf
v_mul_f32_dpp v18, v108, v18 row_newbcast:2 row_mask:0xf bank_mask:0xf
v_mfma_f32_16x16x32_bf16 a[80:83], v[200:203], a[216:219], a[80:83]
ds_read_b64_tr_b16 a[168:169], v14 offset:16384
v_mul_f32_dpp v19, v108, v19 row_newbcast:3 row_mask:0xf bank_mask:0xf
v_mfma_f32_16x16x32_bf16 a[80:83], v[204:207], a[220:223], a[80:83]
ds_read_b64_tr_b16 a[170:171], v14 offset:17408
v_cvt_pk_bf16_f32 v28, v16, v17
v_mfma_f32_16x16x32_bf16 a[84:87], v[220:223], a[220:223], a[84:87]
ds_read_b64_tr_b16 a[172:173], v14 offset:18432
v_cvt_pk_bf16_f32 v29, v18, v19
v_mfma_f32_16x16x32_bf16 a[84:87], v[216:219], a[216:219], a[84:87]
ds_write_b64 v113, v[28:29] offset:2048
v_mfma_f32_16x16x32_bf16 a[84:87], v[212:215], a[212:215], a[84:87]
ds_read_b64_tr_b16 a[174:175], v14 offset:19456
v_accvgpr_read_b32 v20, a76
v_mfma_f32_16x16x32_bf16 a[84:87], v[208:211], a[208:211], a[84:87]
v_accvgpr_read_b32 v21, a77
v_accvgpr_read_b32 v22, a78
v_mfma_f32_16x16x32_bf16 a[84:87], v[156:159], a[188:191], a[84:87]
ds_read_b64_tr_b16 a[192:193], v14 offset:32768
v_accvgpr_read_b32 v23, a79
v_mfma_f32_16x16x32_bf16 a[84:87], v[152:155], a[184:187], a[84:87]
v_mul_f32_dpp v20, v109, v20 row_newbcast:0 row_mask:0xf bank_mask:0xf
v_mul_f32_dpp v21, v109, v21 row_newbcast:1 row_mask:0xf bank_mask:0xf
v_mfma_f32_16x16x32_bf16 a[84:87], v[148:151], a[180:183], a[84:87]
ds_read_b64_tr_b16 a[194:195], v14 offset:33792
v_mul_f32_dpp v22, v109, v22 row_newbcast:2 row_mask:0xf bank_mask:0xf
v_mul_f32_dpp v23, v109, v23 row_newbcast:3 row_mask:0xf bank_mask:0xf
v_mfma_f32_16x16x32_bf16 a[84:87], v[144:147], a[176:179], a[84:87]
ds_read_b64_tr_b16 a[196:197], v14 offset:34816
v_cvt_pk_bf16_f32 v30, v20, v21
v_cvt_pk_bf16_f32 v31, v22, v23
v_mfma_f32_16x16x32_bf16 a[88:91], v[160:163], a[176:179], a[88:91]
ds_read_b64_tr_b16 a[198:199], v14 offset:35840
ds_read_b64_tr_b16 a[200:201], v14 offset:49152
v_mfma_f32_16x16x32_bf16 a[88:91], v[164:167], a[180:183], a[88:91]
ds_write_b64 v113, v[30:31] offset:3072
v_mfma_f32_16x16x32_bf16 a[88:91], v[168:171], a[184:187], a[88:91]
v_accvgpr_read_b32 v16, a80
v_accvgpr_read_b32 v17, a81
v_accvgpr_read_b32 v18, a82
v_mfma_f32_16x16x32_bf16 a[88:91], v[172:175], a[188:191], a[88:91]
ds_read_b64_tr_b16 a[202:203], v14 offset:50176
v_accvgpr_read_b32 v19, a83
v_mfma_f32_16x16x32_bf16 a[88:91], v[224:227], a[208:211], a[88:91]
ds_read_b64_tr_b16 a[204:205], v14 offset:51200
v_mul_f32_dpp v16, v106, v16 row_newbcast:0 row_mask:0xf bank_mask:0xf
v_mul_f32_dpp v17, v106, v17 row_newbcast:1 row_mask:0xf bank_mask:0xf
v_mfma_f32_16x16x32_bf16 a[88:91], v[228:231], a[212:215], a[88:91]
v_mul_f32_dpp v18, v106, v18 row_newbcast:2 row_mask:0xf bank_mask:0xf
v_mul_f32_dpp v19, v106, v19 row_newbcast:3 row_mask:0xf bank_mask:0xf
v_mfma_f32_16x16x32_bf16 a[88:91], v[232:235], a[216:219], a[88:91]
ds_read_b64_tr_b16 a[206:207], v14 offset:52224
v_cvt_pk_bf16_f32 v24, v16, v17
v_cvt_pk_bf16_f32 v25, v18, v19
v_mfma_f32_16x16x32_bf16 a[88:91], v[236:239], a[220:223], a[88:91]
ds_write_b64 v113, v[24:25] offset:128
v_mfma_f32_16x16x32_bf16 a[92:95], v[252:255], a[220:223], a[92:95]
ds_read_b64_tr_b16 v[32:33], v115 offset:0
ds_read_b64_tr_b16 v[34:35], v116 offset:0
v_mfma_f32_16x16x32_bf16 a[92:95], v[248:251], a[216:219], a[92:95]
v_accvgpr_read_b32 v20, a84
v_accvgpr_read_b32 v21, a85
v_mfma_f32_16x16x32_bf16 a[92:95], v[244:247], a[212:215], a[92:95]
v_accvgpr_read_b32 v22, a86
v_accvgpr_read_b32 v23, a87
v_mul_f32_dpp v20, v107, v20 row_newbcast:0 row_mask:0xf bank_mask:0xf
v_mfma_f32_16x16x32_bf16 a[92:95], v[240:243], a[208:211], a[92:95]
v_mul_f32_dpp v21, v107, v21 row_newbcast:1 row_mask:0xf bank_mask:0xf
v_mul_f32_dpp v22, v107, v22 row_newbcast:2 row_mask:0xf bank_mask:0xf
v_mul_f32_dpp v23, v107, v23 row_newbcast:3 row_mask:0xf bank_mask:0xf
v_mfma_f32_16x16x32_bf16 a[92:95], v[188:191], a[188:191], a[92:95]
s_waitcnt lgkmcnt(0)
buffer_store_dwordx4 v[32:35], v101, s[20:23], s48 offen offset:128 sc1
v_mfma_f32_16x16x32_bf16 a[92:95], v[184:187], a[184:187], a[92:95]
v_cvt_pk_bf16_f32 v26, v20, v21
v_cvt_pk_bf16_f32 v27, v22, v23
v_mfma_f32_16x16x32_bf16 a[92:95], v[180:183], a[180:183], a[92:95]
ds_write_b64 v113, v[26:27] offset:1152
v_mfma_f32_16x16x32_bf16 a[92:95], v[176:179], a[176:179], a[92:95]
ds_read_b64_tr_b16 v[36:37], v115 offset:1024
ds_read_b64_tr_b16 v[38:39], v116 offset:1024
v_accvgpr_read_b32 v16, a88
v_mfma_f32_16x16x32_bf16 a[96:99], v[128:131], a[160:163], a[96:99]
ds_read_b64_tr_b16 a[176:177], v15 offset:0
ds_read_b64_tr_b16 a[178:179], v15 offset:1024
ds_read_b64_tr_b16 a[180:181], v15 offset:2048
v_mfma_f32_16x16x32_bf16 a[96:99], v[132:135], a[164:167], a[96:99]
ds_read_b64_tr_b16 a[182:183], v15 offset:3072
ds_read_b64_tr_b16 a[184:185], v15 offset:16384
v_accvgpr_read_b32 v17, a89
v_accvgpr_read_b32 v18, a90
v_mfma_f32_16x16x32_bf16 a[96:99], v[136:139], a[168:171], a[96:99]
ds_read_b64_tr_b16 a[186:187], v15 offset:17408
v_accvgpr_read_b32 v19, a91
v_mul_f32_dpp v16, v108, v16 row_newbcast:0 row_mask:0xf bank_mask:0xf
v_mfma_f32_16x16x32_bf16 a[96:99], v[140:143], a[172:175], a[96:99]
ds_read_b64_tr_b16 a[188:189], v15 offset:18432
v_mul_f32_dpp v17, v108, v17 row_newbcast:1 row_mask:0xf bank_mask:0xf
v_mul_f32_dpp v18, v108, v18 row_newbcast:2 row_mask:0xf bank_mask:0xf
v_mfma_f32_16x16x32_bf16 a[96:99], v[192:195], a[192:195], a[96:99]
ds_read_b64_tr_b16 a[190:191], v15 offset:19456
ds_read_b64_tr_b16 a[208:209], v15 offset:32768
v_mul_f32_dpp v19, v108, v19 row_newbcast:3 row_mask:0xf bank_mask:0xf
v_cvt_pk_bf16_f32 v28, v16, v17
v_mfma_f32_16x16x32_bf16 a[96:99], v[196:199], a[196:199], a[96:99]
ds_read_b64_tr_b16 a[210:211], v15 offset:33792
ds_read_b64_tr_b16 a[212:213], v15 offset:34816
v_cvt_pk_bf16_f32 v29, v18, v19
v_mfma_f32_16x16x32_bf16 a[96:99], v[200:203], a[200:203], a[96:99]
ds_write_b64 v113, v[28:29] offset:2176
ds_read_b64_tr_b16 v[40:41], v115 offset:2048
v_mfma_f32_16x16x32_bf16 a[96:99], v[204:207], a[204:207], a[96:99]
ds_read_b64_tr_b16 a[214:215], v15 offset:35840
ds_read_b64_tr_b16 v[42:43], v116 offset:2048
v_accvgpr_read_b32 v20, a92
v_mfma_f32_16x16x32_bf16 a[100:103], v[220:223], a[204:207], a[100:103]
s_waitcnt lgkmcnt(15)
buffer_store_dwordx4 v[36:39], v101, s[20:23], s49 offen offset:128 sc1
v_mfma_f32_16x16x32_bf16 a[100:103], v[216:219], a[200:203], a[100:103]
v_accvgpr_read_b32 v21, a93
v_accvgpr_read_b32 v22, a94
v_mfma_f32_16x16x32_bf16 a[100:103], v[212:215], a[196:199], a[100:103]
ds_read_b64_tr_b16 a[216:217], v15 offset:49152
v_accvgpr_read_b32 v23, a95
v_mul_f32_dpp v20, v109, v20 row_newbcast:0 row_mask:0xf bank_mask:0xf
v_mfma_f32_16x16x32_bf16 a[100:103], v[208:211], a[192:195], a[100:103]
v_mul_f32_dpp v21, v109, v21 row_newbcast:1 row_mask:0xf bank_mask:0xf
v_mul_f32_dpp v22, v109, v22 row_newbcast:2 row_mask:0xf bank_mask:0xf
v_mul_f32_dpp v23, v109, v23 row_newbcast:3 row_mask:0xf bank_mask:0xf
v_cvt_pk_bf16_f32 v30, v20, v21
v_mfma_f32_16x16x32_bf16 a[100:103], v[156:159], a[172:175], a[100:103]
v_cvt_pk_bf16_f32 v31, v22, v23
v_accvgpr_read_b32 v16, a96
v_accvgpr_read_b32 v17, a97
v_mfma_f32_16x16x32_bf16 a[100:103], v[152:155], a[168:171], a[100:103]
ds_read_b64_tr_b16 a[218:219], v15 offset:50176
v_accvgpr_read_b32 v18, a98
v_accvgpr_read_b32 v19, a99
v_mfma_f32_16x16x32_bf16 a[100:103], v[148:151], a[164:167], a[100:103]
ds_read_b64_tr_b16 a[220:221], v15 offset:51200
v_mul_f32_dpp v16, v106, v16 row_newbcast:0 row_mask:0xf bank_mask:0xf
v_mul_f32_dpp v17, v106, v17 row_newbcast:1 row_mask:0xf bank_mask:0xf
v_mul_f32_dpp v18, v106, v18 row_newbcast:2 row_mask:0xf bank_mask:0xf
v_mfma_f32_16x16x32_bf16 a[100:103], v[144:147], a[160:163], a[100:103]
ds_read_b64_tr_b16 a[222:223], v15 offset:52224
v_mul_f32_dpp v19, v106, v19 row_newbcast:3 row_mask:0xf bank_mask:0xf
v_cvt_pk_bf16_f32 v24, v16, v17
v_cvt_pk_bf16_f32 v25, v18, v19
v_mfma_f32_16x16x32_bf16 a[104:107], v[160:163], a[160:163], a[104:107]
ds_write_b64 v113, v[30:31] offset:3200
v_mfma_f32_16x16x32_bf16 a[104:107], v[164:167], a[164:167], a[104:107]
ds_write_b64 v113, v[24:25] offset:0
v_mfma_f32_16x16x32_bf16 a[104:107], v[168:171], a[168:171], a[104:107]
ds_read_b64_tr_b16 v[44:45], v115 offset:3072
ds_read_b64_tr_b16 v[46:47], v116 offset:3072
v_mfma_f32_16x16x32_bf16 a[104:107], v[172:175], a[172:175], a[104:107]
s_waitcnt lgkmcnt(8)
buffer_store_dwordx4 v[40:43], v101, s[20:23], s50 offen offset:128 sc1
v_mfma_f32_16x16x32_bf16 a[104:107], v[224:227], a[192:195], a[104:107]
v_accvgpr_read_b32 v20, a100
v_accvgpr_read_b32 v21, a101
v_mfma_f32_16x16x32_bf16 a[104:107], v[228:231], a[196:199], a[104:107]
v_accvgpr_read_b32 v22, a102
v_accvgpr_read_b32 v23, a103
v_mfma_f32_16x16x32_bf16 a[104:107], v[232:235], a[200:203], a[104:107]
v_mul_f32_dpp v20, v107, v20 row_newbcast:0 row_mask:0xf bank_mask:0xf
v_mul_f32_dpp v21, v107, v21 row_newbcast:1 row_mask:0xf bank_mask:0xf
v_mul_f32_dpp v22, v107, v22 row_newbcast:2 row_mask:0xf bank_mask:0xf
v_mfma_f32_16x16x32_bf16 a[104:107], v[236:239], a[204:207], a[104:107]
v_mul_f32_dpp v23, v107, v23 row_newbcast:3 row_mask:0xf bank_mask:0xf
v_cvt_pk_bf16_f32 v26, v20, v21
s_waitcnt lgkmcnt(4)
v_mfma_f32_16x16x32_bf16 a[112:115], v[204:207], a[220:223], a[112:115]
v_cvt_pk_bf16_f32 v27, v22, v23
v_mfma_f32_16x16x32_bf16 a[112:115], v[200:203], a[216:219], a[112:115]
ds_write_b64 v113, v[26:27] offset:1024
v_mfma_f32_16x16x32_bf16 a[112:115], v[196:199], a[212:215], a[112:115]
v_mfma_f32_16x16x32_bf16 a[112:115], v[192:195], a[208:211], a[112:115]
v_mfma_f32_16x16x32_bf16 a[112:115], v[140:143], a[188:191], a[112:115]
v_accvgpr_read_b32 v16, a104
v_accvgpr_read_b32 v17, a105
v_accvgpr_read_b32 v18, a106
v_mfma_f32_16x16x32_bf16 a[112:115], v[136:139], a[184:187], a[112:115]
v_accvgpr_read_b32 v19, a107
v_mul_f32_dpp v16, v108, v16 row_newbcast:0 row_mask:0xf bank_mask:0xf
v_mfma_f32_16x16x32_bf16 a[112:115], v[132:135], a[180:183], a[112:115]
v_mul_f32_dpp v17, v108, v17 row_newbcast:1 row_mask:0xf bank_mask:0xf
v_mul_f32_dpp v18, v108, v18 row_newbcast:2 row_mask:0xf bank_mask:0xf
v_mfma_f32_16x16x32_bf16 a[112:115], v[128:131], a[176:179], a[112:115]
v_mul_f32_dpp v19, v108, v19 row_newbcast:3 row_mask:0xf bank_mask:0xf
v_cvt_pk_bf16_f32 v28, v16, v17
v_cvt_pk_bf16_f32 v29, v18, v19
v_mfma_f32_16x16x32_bf16 a[116:119], v[144:147], a[176:179], a[116:119]
ds_write_b64 v113, v[28:29] offset:2048
v_mfma_f32_16x16x32_bf16 a[116:119], v[148:151], a[180:183], a[116:119]
v_mfma_f32_16x16x32_bf16 a[116:119], v[152:155], a[184:187], a[116:119]
s_waitcnt lgkmcnt(2)
buffer_store_dwordx4 v[44:47], v101, s[20:23], s51 offen offset:128 sc1
v_mfma_f32_16x16x32_bf16 a[116:119], v[156:159], a[188:191], a[116:119]
v_mfma_f32_16x16x32_bf16 a[116:119], v[208:211], a[208:211], a[116:119]
v_accvgpr_read_b32 v20, a112
v_accvgpr_read_b32 v21, a113
v_accvgpr_read_b32 v22, a114
v_mfma_f32_16x16x32_bf16 a[116:119], v[212:215], a[212:215], a[116:119]
v_accvgpr_read_b32 v23, a115
v_mul_f32_dpp v20, v106, v20 row_newbcast:0 row_mask:0xf bank_mask:0xf
v_mfma_f32_16x16x32_bf16 a[116:119], v[216:219], a[216:219], a[116:119]
v_mul_f32_dpp v21, v106, v21 row_newbcast:1 row_mask:0xf bank_mask:0xf
v_mul_f32_dpp v22, v106, v22 row_newbcast:2 row_mask:0xf bank_mask:0xf
v_mfma_f32_16x16x32_bf16 a[116:119], v[220:223], a[220:223], a[116:119]
v_mul_f32_dpp v23, v106, v23 row_newbcast:3 row_mask:0xf bank_mask:0xf
v_cvt_pk_bf16_f32 v30, v20, v21
v_cvt_pk_bf16_f32 v31, v22, v23
v_mfma_f32_16x16x32_bf16 a[120:123], v[236:239], a[220:223], a[120:123]
ds_write_b64 v113, v[30:31] offset:128
v_mfma_f32_16x16x32_bf16 a[120:123], v[232:235], a[216:219], a[120:123]
ds_read_b64_tr_b16 v[32:33], v115 offset:0
ds_read_b64_tr_b16 v[34:35], v116 offset:0
v_mfma_f32_16x16x32_bf16 a[120:123], v[228:231], a[212:215], a[120:123]
v_mfma_f32_16x16x32_bf16 a[120:123], v[224:227], a[208:211], a[120:123]
v_mfma_f32_16x16x32_bf16 a[120:123], v[172:175], a[188:191], a[120:123]
v_accvgpr_read_b32 v16, a116
v_accvgpr_read_b32 v17, a117
v_accvgpr_read_b32 v18, a118
v_accvgpr_read_b32 v19, a119
v_mfma_f32_16x16x32_bf16 a[120:123], v[168:171], a[184:187], a[120:123]
v_mul_f32_dpp v16, v107, v16 row_newbcast:0 row_mask:0xf bank_mask:0xf
v_mul_f32_dpp v17, v107, v17 row_newbcast:1 row_mask:0xf bank_mask:0xf
v_mul_f32_dpp v18, v107, v18 row_newbcast:2 row_mask:0xf bank_mask:0xf
v_mfma_f32_16x16x32_bf16 a[120:123], v[164:167], a[180:183], a[120:123]
s_waitcnt lgkmcnt(0)
buffer_store_dwordx4 v[32:35], v101, s[20:23], s48 offen offset:192 sc1
v_mfma_f32_16x16x32_bf16 a[120:123], v[160:163], a[176:179], a[120:123]
v_mul_f32_dpp v19, v107, v19 row_newbcast:3 row_mask:0xf bank_mask:0xf
v_cvt_pk_bf16_f32 v24, v16, v17
v_mfma_f32_16x16x32_bf16 a[108:111], v[176:179], a[160:163], a[108:111]
v_cvt_pk_bf16_f32 v25, v18, v19
v_mfma_f32_16x16x32_bf16 a[108:111], v[180:183], a[164:167], a[108:111]
ds_write_b64 v113, v[24:25] offset:1152
ds_read_b64_tr_b16 v[36:37], v115 offset:1024
v_mfma_f32_16x16x32_bf16 a[108:111], v[184:187], a[168:171], a[108:111]
ds_read_b64_tr_b16 v[38:39], v116 offset:1024
v_mfma_f32_16x16x32_bf16 a[108:111], v[188:191], a[172:175], a[108:111]
v_mfma_f32_16x16x32_bf16 a[108:111], v[240:243], a[192:195], a[108:111]
v_accvgpr_read_b32 v20, a120
v_accvgpr_read_b32 v21, a121
v_accvgpr_read_b32 v22, a122
v_accvgpr_read_b32 v23, a123
v_mfma_f32_16x16x32_bf16 a[108:111], v[244:247], a[196:199], a[108:111]
v_mul_f32_dpp v20, v108, v20 row_newbcast:0 row_mask:0xf bank_mask:0xf
v_mul_f32_dpp v21, v108, v21 row_newbcast:1 row_mask:0xf bank_mask:0xf
v_mul_f32_dpp v22, v108, v22 row_newbcast:2 row_mask:0xf bank_mask:0xf
v_mfma_f32_16x16x32_bf16 a[108:111], v[248:251], a[200:203], a[108:111]
s_waitcnt lgkmcnt(0)
buffer_store_dwordx4 v[36:39], v101, s[20:23], s49 offen offset:192 sc1
v_mfma_f32_16x16x32_bf16 a[108:111], v[252:255], a[204:207], a[108:111]
v_mul_f32_dpp v23, v108, v23 row_newbcast:3 row_mask:0xf bank_mask:0xf
v_cvt_pk_bf16_f32 v26, v20, v21
v_mfma_f32_16x16x32_bf16 a[124:127], v[252:255], a[220:223], a[124:127]
v_cvt_pk_bf16_f32 v27, v22, v23
v_mfma_f32_16x16x32_bf16 a[124:127], v[248:251], a[216:219], a[124:127]
ds_write_b64 v113, v[26:27] offset:2176
ds_read_b64_tr_b16 v[40:41], v115 offset:2048
v_mfma_f32_16x16x32_bf16 a[124:127], v[244:247], a[212:215], a[124:127]
ds_read_b64_tr_b16 v[42:43], v116 offset:2048
v_mfma_f32_16x16x32_bf16 a[124:127], v[240:243], a[208:211], a[124:127]
v_mfma_f32_16x16x32_bf16 a[124:127], v[188:191], a[188:191], a[124:127]
v_accvgpr_read_b32 v16, a108
v_accvgpr_read_b32 v17, a109
v_accvgpr_read_b32 v18, a110
v_accvgpr_read_b32 v19, a111
v_mul_f32_dpp v16, v109, v16 row_newbcast:0 row_mask:0xf bank_mask:0xf
v_mfma_f32_16x16x32_bf16 a[124:127], v[184:187], a[184:187], a[124:127]
v_mul_f32_dpp v17, v109, v17 row_newbcast:1 row_mask:0xf bank_mask:0xf
v_mul_f32_dpp v18, v109, v18 row_newbcast:2 row_mask:0xf bank_mask:0xf
v_mul_f32_dpp v19, v109, v19 row_newbcast:3 row_mask:0xf bank_mask:0xf
v_cvt_pk_bf16_f32 v28, v16, v17
v_mfma_f32_16x16x32_bf16 a[124:127], v[180:183], a[180:183], a[124:127]
s_waitcnt lgkmcnt(0)
buffer_store_dwordx4 v[40:43], v101, s[20:23], s50 offen offset:192 sc1
v_mfma_f32_16x16x32_bf16 a[124:127], v[176:179], a[176:179], a[124:127]
v_cvt_pk_bf16_f32 v29, v18, v19
ds_write_b64 v113, v[28:29] offset:3072
s_nop 5
v_accvgpr_read_b32 v20, a124
v_accvgpr_read_b32 v21, a125
v_accvgpr_read_b32 v22, a126
v_accvgpr_read_b32 v23, a127
v_mul_f32_dpp v20, v109, v20 row_newbcast:0 row_mask:0xf bank_mask:0xf
v_mul_f32_dpp v21, v109, v21 row_newbcast:1 row_mask:0xf bank_mask:0xf
v_mul_f32_dpp v22, v109, v22 row_newbcast:2 row_mask:0xf bank_mask:0xf
v_mul_f32_dpp v23, v109, v23 row_newbcast:3 row_mask:0xf bank_mask:0xf
v_cvt_pk_bf16_f32 v30, v20, v21
v_cvt_pk_bf16_f32 v31, v22, v23
ds_write_b64 v113, v[30:31] offset:3200
ds_read_b64_tr_b16 v[44:45], v115 offset:3072
ds_read_b64_tr_b16 v[46:47], v116 offset:3072
s_waitcnt lgkmcnt(0)
buffer_store_dwordx4 v[44:47], v101, s[20:23], s51 offen offset:192 sc1
s_waitcnt lgkmcnt(0)
s_barrier
ds_read_b128 v[122:125], v126
s_waitcnt lgkmcnt(0)
v_or3_b32 v122, v122, v123, v124
v_or_b32 v122, v122, v125
s_nop 0
v_readfirstlane_b32 s29, v122
s_nop 0
s_cmp_lg_u32 s29, 0
s_cselect_b32 s5, 1, 0
s_cmp_gt_u32 s5, s28
s_cbranch_scc1 L_fallback
L_end:
s_endpgm
L_fallback:
s_waitcnt vmcnt(0) lgkmcnt(0)
s_barrier
s_mov_b32 s28, 1
s_mov_b32 s24, 0
v_lshlrev_b32 v122, 8, v2
v_lshl_add_u32 v122, v3, 4, v122
L_fb_loop:
buffer_load_dwordx4 a[160:163], v122, s[8:11], s24 offen offset:0
buffer_load_dwordx4 a[164:167], v122, s[8:11], s24 offen offset:64
buffer_load_dwordx4 a[168:171], v122, s[8:11], s24 offen offset:128
buffer_load_dwordx4 a[172:175], v122, s[8:11], s24 offen offset:192
s_waitcnt vmcnt(0)
v_mfma_f32_16x16x32_bf16 v[16:19], a[160:163], a[128:131], 0
v_mfma_f32_16x16x32_bf16 v[16:19], a[164:167], a[132:135], v[16:19]
v_mfma_f32_16x16x32_bf16 v[16:19], a[168:171], a[136:139], v[16:19]
v_mfma_f32_16x16x32_bf16 v[16:19], a[172:175], a[140:143], v[16:19]
v_mfma_f32_16x16x32_bf16 v[20:23], a[172:175], a[156:159], 0
v_mfma_f32_16x16x32_bf16 v[20:23], a[168:171], a[152:155], v[20:23]
v_mfma_f32_16x16x32_bf16 v[20:23], a[164:167], a[148:151], v[20:23]
v_mfma_f32_16x16x32_bf16 v[20:23], a[160:163], a[144:147], v[20:23]
v_mfma_f32_16x16x32_bf16 v[24:27], a[160:163], v[64:67], 0
v_mfma_f32_16x16x32_bf16 v[24:27], a[164:167], v[68:71], v[24:27]
v_mfma_f32_16x16x32_bf16 v[24:27], a[168:171], v[72:75], v[24:27]
v_mfma_f32_16x16x32_bf16 v[24:27], a[172:175], v[76:79], v[24:27]
v_mfma_f32_16x16x32_bf16 v[28:31], a[172:175], v[92:95], 0
v_mfma_f32_16x16x32_bf16 v[28:31], a[168:171], v[88:91], v[28:31]
v_mfma_f32_16x16x32_bf16 v[28:31], a[164:167], v[84:87], v[28:31]
v_mfma_f32_16x16x32_bf16 v[28:31], a[160:163], v[80:83], v[28:31]
s_nop 7
v_max3_f32 v102, v16, v17, v102
v_max3_f32 v102, v18, v19, v102
v_max3_f32 v103, v20, v21, v103
v_max3_f32 v103, v22, v23, v103
v_max3_f32 v104, v24, v25, v104
v_max3_f32 v104, v26, v27, v104
v_max3_f32 v105, v28, v29, v105
v_max3_f32 v105, v30, v31, v105
s_add_u32 s24, s24, 4096
s_cmp_lt_u32 s24, 524288
s_cbranch_scc1 L_fb_loop
s_branch L_restart
.section .rodata,"a"
.p2align 6
.amdhsa_kernel standalone__softmax_full_bidir__prompt_kernel
  .amdhsa_next_free_vgpr 512
  .amdhsa_next_free_sgpr 100
  .amdhsa_accum_offset 256
  .amdhsa_group_segment_fixed_size 0
  .amdhsa_kernarg_size 48
  .amdhsa_user_sgpr_count 2
  .amdhsa_user_sgpr_kernarg_segment_ptr 1
  .amdhsa_system_sgpr_workgroup_id_x 1
.end_amdhsa_kernel
```
